```python
import torch

def _softmax(x, axis=-1):
    return torch.softmax(x, dim=axis)
def _gelu(x):
    return torch.nn.functional.gelu(x, approximate="tanh")
def _silu(x):
    return torch.nn.functional.silu(x)
def _sigmoid(x):
    return torch.sigmoid(x)
def _layernorm(x, axis=-1, eps=1e-5):
    m = x.mean(dim=axis, keepdim=True)
    v = x.var(dim=axis, keepdim=True, unbiased=False)
    return (x - m) / torch.sqrt(v + eps)
def _scatter_add(tgt, idx, src, axis=0):
    return tgt.clone().index_add_(axis, idx, src)
def _segment_sum(src, seg, n):
    out = torch.zeros((n,) + src.shape[1:], dtype=src.dtype)
    return out.index_add_(0, seg, src)
def _pad(x, pw):
    flat = tuple(v for pair in reversed(pw) for v in pair)
    return torch.nn.functional.pad(x, flat)

kernel_name = 'recurrent_scan__ssm_conv_s5__mixer_s_mlp__prompt'

def setup_inputs():

    _w = (lambda a: (lambda t: t.to(torch.bfloat16) if t.is_floating_point() else t)(torch.as_tensor(a)))
    def _A_setup():
        B, S, D = 1, 2048, 512
        P = D
        Lambda_re = -0.5 * (lambda _x: torch.exp(torch.as_tensor(_x)))((lambda *s: torch.randn(*s, dtype=torch.bfloat16) * 0.2)(P))
        Lambda_im = (lambda *s: torch.randn(*s, dtype=torch.bfloat16) * 0.4)(P) * 1.0
        B_re = (lambda *s: torch.randn(*s, dtype=torch.bfloat16) * 0.2)(P, D) * (D ** -0.5)
        B_im = (lambda *s: torch.randn(*s, dtype=torch.bfloat16) * 0.2)(P, D) * (D ** -0.5)
        C_re = (lambda *s: torch.randn(*s, dtype=torch.bfloat16) * 0.2)(D, P) * (P ** -0.5)
        C_im = (lambda *s: torch.randn(*s, dtype=torch.bfloat16) * 0.2)(D, P) * (P ** -0.5)
        log_dt = (lambda *s: torch.randn(*s, dtype=torch.bfloat16) * 0.2)(P) * 0.3 - 2.0
        Dskip = (lambda *s: torch.randn(*s, dtype=torch.bfloat16) * 0.05)(D)
        return {
            "x": _w((lambda *s: torch.randn(*s, dtype=torch.bfloat16) * 0.05)(B, S, D)),
            "Lambda_re": _w(Lambda_re),
            "Lambda_im": _w(Lambda_im),
            "B_re": _w(B_re),
            "B_im": _w(B_im),
            "C_re": _w(C_re),
            "C_im": _w(C_im),
            "log_dt": _w(log_dt),
            "Dskip": _w(Dskip),
        }
    _A_in = _A_setup()

    def _B_setup():
        B, S, D, F = 1, 2048, 512, 1792
        return {
            "x":  _w((lambda *s: torch.randn(*s, dtype=torch.bfloat16) * 0.05)(B, S, D)),
            "w1": _w((lambda *s: torch.randn(*s, dtype=torch.bfloat16) * 3.2)(D, D) * (D ** -0.5)),
            "w2": _w((lambda *s: torch.randn(*s, dtype=torch.bfloat16) * 3.2)(D, D) * (D ** -0.5)),
            "w3": _w((lambda *s: torch.randn(*s, dtype=torch.bfloat16) * 3.2)(D, F) * (D ** -0.5)),
            "w4": _w((lambda *s: torch.randn(*s, dtype=torch.bfloat16) * 3.2)(F, D) * (F ** -0.5)),
        }
    _B_in = _B_setup()

    return {
        "A_x": _A_in["x"],
        "A_Lambda_re": _A_in["Lambda_re"],
        "A_Lambda_im": _A_in["Lambda_im"],
        "A_B_re": _A_in["B_re"],
        "A_B_im": _A_in["B_im"],
        "A_C_re": _A_in["C_re"],
        "A_C_im": _A_in["C_im"],
        "A_log_dt": _A_in["log_dt"],
        "A_Dskip": _A_in["Dskip"],
        "B_x": _B_in["x"],
        "B_w1": _B_in["w1"],
        "B_w2": _B_in["w2"],
        "B_w3": _B_in["w3"],
        "B_w4": _B_in["w4"],
    }

def reference(A_x, A_Lambda_re, A_Lambda_im, A_B_re, A_B_im, A_C_re, A_C_im, A_log_dt, A_Dskip, B_x, B_w1, B_w2, B_w3, B_w4):
    def _A_ref(x, Lambda_re, Lambda_im, B_re, B_im, C_re, C_im, log_dt, Dskip):
        Bsz, L, H = x.shape
        Lam = Lambda_re + 1j * Lambda_im
        Bmat = B_re + 1j * B_im
        Cmat = C_re + 1j * C_im
        dt = torch.exp(log_dt)
        Lam_bar = torch.exp(dt * Lam)
        B_bar = ((Lam_bar - 1.0) / Lam)[:, None] * Bmat
        Bu = torch.einsum("bld,pd->blp", x + 0j, B_bar)
        h = torch.zeros_like(Bu[:, 0, :])
        hs = []
        for t in range(L):
            h = Lam_bar[None, :] * h + Bu[:, t, :]
            hs.append(h)
        hseq = torch.stack(hs, 1)
        y = 2.0 * torch.einsum("blp,dp->bld", hseq, Cmat).real + x * Dskip[None, None, :]
        return y

    def _B_ref(x, w1, w2, w3, w4):
        B, S, D = x.shape
        h = _gelu(_layernorm(x, axis=-1) @ w1)
        c = D // 4
        g0 = _pad(h[:, :, 0*c:1*c], ((0, 0), (1, 0), (0, 0)))[:, :S, :]
        g1 = _pad(h[:, :, 1*c:2*c], ((0, 0), (0, 1), (0, 0)))[:, 1:, :]
        g2 = _pad(h[:, :, 2*c:3*c], ((0, 0), (2, 0), (0, 0)))[:, :S, :]
        g3 = _pad(h[:, :, 3*c:   ], ((0, 0), (0, 2), (0, 0)))[:, 2:, :]
        hs = torch.concatenate([g0, g1, g2, g3], axis=-1) @ w2
        x1 = x + hs
        h2 = _gelu(_layernorm(x1, axis=-1) @ w3) @ w4
        return x1 + h2

    x = A_x
    xn = _layernorm(x, axis=-1)
    s = _A_ref(xn, A_Lambda_re, A_Lambda_im, A_B_re, A_B_im, A_C_re, A_C_im, A_log_dt, A_Dskip)
    g = _silu(_B_ref(xn, B_w1, B_w2, B_w3, B_w4))
    return x + s * g
```

```asm
; @launch grid=(256,1,1) block=(256,1,1) lds=163840
.amdgcn_target "amdgcn-amd-amdhsa--gfx950"
.text
.globl recurrent_scan__ssm_conv_s5__mixer_s_mlp__prompt_kernel
.p2align 12
.type recurrent_scan__ssm_conv_s5__mixer_s_mlp__prompt_kernel,@function
recurrent_scan__ssm_conv_s5__mixer_s_mlp__prompt_kernel:
  s_cmp_ge_u32 s2, 256
  s_cbranch_scc1 L_end
  s_load_dwordx16 s[16:31], s[0:1], 0
  s_load_dwordx16 s[32:47], s[0:1], 64
  s_load_dwordx2 s[48:49], s[0:1], 128
  s_getpc_b64 s[50:51]
L_pc:
  s_lshr_b32 s6, s2, 3
  s_lshl_b32 s6, s6, 11
  v_lshl_add_u32 v255, v0, 3, s6
  v_min_u32 v255, L_codeend-L_pc-4, v255
  global_load_dword v255, v255, s[50:51]
  v_and_b32 v1, 63, v0
  v_lshrrev_b32 v2, 6, v0
  s_nop 0
  v_readfirstlane_b32 s5, v2
  s_and_b32 s3, s2, 7
  s_lshl_b32 s3, s3, 1
  s_lshr_b32 s6, s2, 7
  s_add_u32 s3, s3, s6
  s_lshr_b32 s4, s2, 3
  s_and_b32 s4, s4, 15
  v_and_b32 v6, 31, v1
  v_lshrrev_b32 v7, 5, v1
  v_lshlrev_b32 v8, 4, v1
  s_lshl_b32 s9, s3, 7
  s_add_u32 s10, s4, 0
  s_and_b32 s10, s10, 7
  s_cmp_eq_u32 s10, 3
  s_cselect_b32 s10, 4, s10
  s_lshl_b32 s10, s10, 7
  s_lshl_b32 s7, s5, 8
  s_add_u32 s7, s7, s10
  v_lshrrev_b32 v2, 1, v6
  v_lshl_add_u32 v2, v2, 4, s7
  v_and_b32 v2, 1023, v2
  v_and_b32 v3, 1, v1
  v_lshl_add_u32 v18, v3, 10, v2
  s_bitcmp1_b32 s4, 2
  s_cselect_b32 s8, 128, -2
  s_add_u32 s8, s8, s9
  s_lshl_b32 s8, s8, 10
  v_add_u32 v18, s8, v18
  s_lshl_b32 s8, s7, 9
  s_and_b32 s8, s8, 0x70000
  s_add_u32 s11, s8, 0x10000
  s_and_b32 s11, s11, 0x70000
  v_bfe_u32 v2, v1, 3, 1
  v_lshlrev_b32 v2, 14, v2
  v_lshrrev_b32 v3, 4, v1
  v_lshl_add_u32 v2, v3, 12, v2
  v_and_b32 v3, 1, v3
  v_and_b32 v4, 7, v1
  v_xor_b32 v3, v3, v4
  v_lshl_add_u32 v19, v3, 4, v2
  s_lshl_b32 s7, s5, 5
  s_add_u32 s6, s9, s7
  s_lshl_b32 s6, s6, 10
  v_add_u32 v19, s6, v19
  v_xor_b32 v21, 32, v19
  v_xor_b32 v22, 64, v19
  v_xor_b32 v23, 96, v19
  s_lshl_b32 s14, s5, 12
  s_add_u32 s14, s14, 132096
  s_mul_i32 s15, s5, 8320
  s_add_u32 s15, s15, 98816
  s_lshl_b32 s92, s5, 13
  v_lshrrev_b32 v2, 2, v1
  v_lshlrev_b32 v2, 10, v2
  v_and_b32 v3, 3, v1
  v_lshl_add_u32 v24, v3, 4, v2
  s_lshl_b32 s7, s4, 6
  v_add_u32 v20, s7, v24
  v_mov_b32 v248, 0x3f803f80
  v_mov_b32 v249, 0x3f803f80
  v_mov_b32 v250, 0x3f803f80
  v_mov_b32 v251, 0x3f803f80
  s_lshr_b32 s93, s2, 3
  s_lshl_b32 s93, s93, 2
  s_add_u32 s93, s93, s5
  s_lshl_b32 s6, s93, 12
  v_lshlrev_b32 v0, 7, v1
  s_mov_b32 s9, 21495808
  s_lshl_b32 s7, s3, 17
  s_lshl_b32 s13, s4, 13
  s_add_u32 s7, s7, s13
  s_lshl_b32 s13, s5, 11
  s_add_u32 s7, s7, s13
  s_add_u32 s7, s7, 384
  v_lshlrev_b32 v5, 10, v1
  s_mov_b32 m0, 156416
  s_waitcnt lgkmcnt(0)
  s_mov_b32 s52, s16
  s_and_b32 s53, s17, 0xffff
  s_mov_b32 s54, 2097152
  s_mov_b32 s55, 0x20000
  s_mov_b64 exec, 3
  buffer_load_dword v5, s[52:55], s7 offen lds
  s_mov_b64 exec, -1
  s_mov_b32 s72, s36
  s_and_b32 s73, s37, 0xffff
  s_mov_b32 s74, 524288
  s_mov_b32 s75, 0x20000
  s_mov_b32 exec_hi, 0
  buffer_load_dword v0, s[72:75], s6 offen lds
  s_mov_b64 exec, -1
  s_load_dword s12, s[48:49], s9
  s_mov_b32 s94, s8
  v_add_u32 v25, s10, v8
  v_and_b32 v25, 1023, v25
  s_mov_b32 exec_hi, 0
  buffer_load_dwordx4 v[248:251], v18, s[52:55], 0 offen
  s_mov_b64 exec, -1
  s_mov_b32 m0, s14
  s_nop 0
  buffer_load_dwordx4 v19, s[52:55], s10 offen offset:0 lds
  buffer_load_dwordx4 v21, s[52:55], s10 offen offset:1024 lds
  buffer_load_dwordx4 v22, s[52:55], s10 offen offset:2048 lds
  buffer_load_dwordx4 v23, s[52:55], s10 offen offset:3072 lds
  s_lshl_b32 s6, s4, 6
  v_lshl_add_u32 v18, v6, 1, s6
  global_load_ushort v26, v18, s[18:19]
  global_load_ushort v27, v18, s[20:21]
  global_load_ushort v28, v18, s[30:31]
  s_mov_b32 s56, s22
  s_and_b32 s57, s23, 0xffff
  s_mov_b32 s58, 524288
  s_mov_b32 s59, 0x20000
  s_mov_b32 s60, s24
  s_and_b32 s61, s25, 0xffff
  s_mov_b32 s62, 524288
  s_mov_b32 s63, 0x20000
  s_mov_b32 s88, s48
  s_and_b32 s89, s49, 0xffff
  s_mov_b32 s90, 268435456
  s_mov_b32 s91, 0x20000
  s_mov_b32 s76, s38
  s_and_b32 s77, s39, 0xffff
  s_mov_b32 s78, 524288
  s_mov_b32 s79, 0x20000
  s_mov_b32 s80, s40
  s_and_b32 s81, s41, 0xffff
  s_mov_b32 s82, 1835008
  s_mov_b32 s83, 0x20000
  s_mov_b32 s84, s42
  s_and_b32 s85, s43, 0xffff
  s_mov_b32 s86, 1835008
  s_mov_b32 s87, 0x20000
  s_mov_b32 s64, s26
  s_and_b32 s65, s27, 0xffff
  s_mov_b32 s66, 524288
  s_mov_b32 s67, 0x20000
  s_mov_b32 s68, s28
  s_and_b32 s69, s29, 0xffff
  s_mov_b32 s70, 524288
  s_mov_b32 s71, 0x20000
  s_and_b32 s13, s2, 7
  s_lshl_b32 s13, s13, 7
  s_add_u32 s13, s13, s93
  s_mul_i32 s13, s13, 512
  s_mov_b32 m0, 156416
  s_mov_b64 exec, 15
  buffer_load_dword v0, s[56:59], s13 offen lds
  s_mov_b64 exec, -1
  s_and_b32 s13, s2, 7
  s_lshl_b32 s13, s13, 7
  s_add_u32 s13, s13, s93
  s_mul_i32 s13, s13, 512
  s_mov_b32 m0, 156416
  s_mov_b64 exec, 15
  buffer_load_dword v0, s[76:79], s13 offen lds
  s_mov_b64 exec, -1
  s_and_b32 s13, s2, 7
  s_lshl_b32 s13, s13, 7
  s_add_u32 s13, s13, s93
  s_mul_i32 s13, s13, 512
  s_mov_b32 m0, 156416
  s_mov_b64 exec, 15
  buffer_load_dword v0, s[60:63], s13 offen lds
  s_mov_b64 exec, -1
  s_and_b32 s45, s45, 0xffff
  s_mov_b32 s46, 4194304
  s_mov_b32 s47, 0x20000
  s_and_b32 s33, s33, 0xffff
  s_mov_b32 s34, 1024
  s_mov_b32 s35, 0x20000
  s_getreg_b32 s19, hwreg(HW_REG_XCC_ID)
  s_and_b32 s19, s19, 15
  s_mul_i32 s16, s3, 1179648
  s_lshl_b32 s20, s4, 11
  s_add_u32 s20, s20, s16
  s_add_u32 s20, s20, 131072
  v_accvgpr_write_b32 a252, -1
  v_accvgpr_write_b32 a253, -1
  v_accvgpr_write_b32 a254, -1
  v_accvgpr_write_b32 a255, -1
  s_lshl_b32 s7, s5, 15
  s_add_u32 s7, s7, s20
  buffer_store_dwordx4 a[252:255], v8, s[88:91], s7 offen sc0 sc1
  buffer_store_dwordx4 a[252:255], v8, s[88:91], s7 offen offset:1024 sc0 sc1
  s_mov_b64 exec, 0
  s_cmp_eq_u32 s5, 0
  s_cbranch_scc1 L_stub0
  s_cmp_eq_u32 s5, 1
  s_cbranch_scc1 L_stub1
  s_cmp_eq_u32 s5, 2
  s_cbranch_scc1 L_stub2
  s_cmp_eq_u32 s5, 3
  s_cbranch_scc1 L_stub3
L_stubret:
  s_mov_b64 exec, -1
  v_mov_b32 v12, 0
  s_waitcnt lgkmcnt(0)
  s_add_u32 s17, s12, 16
  s_and_b32 s17, s17, -16
  v_mov_b32 v11, s17
  s_or_b32 s6, s17, s19
  v_mov_b32 v2, s6
  s_lshl_b32 s7, s4, 7
  s_add_u32 s7, s7, s16
  s_add_u32 s7, s7, 1150976
  s_mov_b64 exec, 1
  s_cmp_lg_u32 s5, 0
  s_cselect_b32 s7, 0x80000000, s7
  buffer_store_dword v2, v12, s[88:91], s7 offen sc0 sc1
  s_mov_b64 exec, -1
  s_lshr_b32 s12, s4, 3
  s_and_b32 s21, s4, 7
  s_and_b32 s22, s5, 1
  s_lshr_b32 s23, s5, 1
  v_mov_b32 v10, 0xffff0000
  v_lshlrev_b32 v13, 2, v1
  v_mov_b32 v18, 0x3f803f80
  v_lshrrev_b32 v2, 2, v1
  v_lshrrev_b32 v3, 4, v1
  v_xor_b32 v2, v2, v3
  v_and_b32 v2, 1, v2
  v_cmp_eq_u32 vcc, 0, v2
  s_nop 1
  v_cndmask_b32 v224, 0, v18, vcc
  v_cndmask_b32 v225, 0, v18, vcc
  v_cndmask_b32 v226, 0, v18, vcc
  v_cndmask_b32 v227, 0, v18, vcc
  s_lshl_b32 s6, s5, 10
  s_add_u32 s6, s6, 156672
  v_lshrrev_b32 v2, 1, v6
  v_lshlrev_b32 v2, 6, v2
  v_and_b32 v3, 1, v1
  v_lshl_add_u32 v2, v3, 4, v2
  v_lshl_add_u32 v2, v7, 5, v2
  v_add_u32 v29, s6, v2
  s_add_u32 s7, s16, 1150976
  v_and_b32 v31, 15, v1
  v_lshl_add_u32 v31, v31, 7, s7
  s_bitcmp1_b32 s4, 2
  s_cselect_b32 s7, 15, 0
  s_cmp_eq_u32 s3, s7
  s_cselect_b32 s26, 0, -1
  s_lshl_b32 s27, s4, 15
  s_add_u32 s27, s27, s92
  v_bfe_u32 v3, v1, 4, 1
  v_lshlrev_b32 v2, 5, v3
  v_and_b32 v3, 1, v1
  v_lshl_add_u32 v2, v3, 4, v2
  v_bfe_u32 v3, v1, 1, 1
  v_lshl_add_u32 v4, v3, 3, v2
  v_bfe_u32 v2, v1, 2, 2
  v_lshl_add_u32 v16, v2, 6, v4
  v_lshl_add_u32 v16, v7, 9, v16
  v_add_u32 v32, 65536, v16
  v_lshl_add_u32 v4, v2, 7, v4
  v_lshl_add_u32 v4, v7, 10, v4
  v_bfe_u32 v3, v1, 3, 1
  v_xor_b32 v3, s22, v3
  s_lshl_b32 s6, s22, 15
  v_add_u32 v4, s6, v4
  v_lshl_add_u32 v119, v3, 6, v4
  v_xor_b32 v120, 64, v119
  v_and_b32 v2, 3, v1
  v_mul_u32_u24 v2, 1056, v2
  v_lshrrev_b32 v3, 2, v6
  v_lshl_add_u32 v2, v3, 7, v2
  v_bfe_u32 v3, v1, 3, 1
  v_xor_b32 v3, v3, v7
  v_lshl_add_u32 v2, v3, 4, v2
  v_add_u32 v176, s14, v2
  v_add_u32 v152, s92, v2
  v_add_u32 v156, s15, v2
  v_xor_b32 v177, 32, v176
  v_xor_b32 v178, 64, v176
  v_xor_b32 v179, 96, v176
  v_xor_b32 v153, 32, v152
  v_xor_b32 v154, 64, v152
  v_xor_b32 v155, 96, v152
  v_xor_b32 v157, 32, v156
  v_xor_b32 v158, 64, v156
  v_xor_b32 v159, 96, v156
  s_lshr_b32 s6, s4, 3
  s_add_u32 s9, s6, 1
  s_sub_u32 s7, 0, s9
  s_bitcmp1_b32 s4, 2
  s_cselect_b32 s9, s7, s9
  v_and_b32 v104, 1, v1
  v_lshlrev_b32 v109, 3, v104
  v_add_u32 v109, 163584, v109
  v_lshlrev_b32 v104, 7, v104
  v_lshrrev_b32 v105, 1, v1
  v_lshl_add_u32 v104, v105, 2, v104
  v_add_u32 v104, 160768, v104
  v_lshlrev_b32 v106, 2, v105
  v_add_u32 v107, 161024, v106
  s_lshl_b32 s6, s5, 7
  s_add_u32 s6, s6, 162304
  v_add_u32 v106, s6, v106
  v_lshl_add_u32 v108, v7, 6, s6
  v_bfe_u32 v96, v6, 2, 1
  v_lshlrev_b32 v96, 4, v96
  v_lshrrev_b32 v97, 3, v6
  v_lshl_add_u32 v96, v97, 2, v96
  v_and_b32 v97, 3, v6
  v_add_u32 v9, v96, v97
  s_bitcmp1_b32 s4, 2
  s_cselect_b32 s7, 128, -2
  s_add_u32 s7, s7, s9
  v_and_b32 v98, 1, v1
  v_add_u32 v98, s7, v98
  v_bfe_u32 v100, v98, 2, 2
  v_lshlrev_b32 v100, 3, v100
  v_bfe_u32 v101, v98, 4, 1
  v_lshl_add_u32 v100, v101, 2, v100
  v_and_b32 v101, 3, v98
  v_add_u32 v100, v100, v101
  v_lshlrev_b32 v100, 4, v100
  v_lshrrev_b32 v101, 5, v98
  v_lshl_add_u32 v100, v101, 15, v100
  v_cmp_gt_u32 vcc, 128, v98
  v_bfrev_b32 v101, 1
  s_nop 0
  v_cndmask_b32 v99, v101, v100, vcc
  v_bfe_u32 v100, v105, 3, 1
  v_lshl_add_u32 v99, v100, 10, v99
  v_lshrrev_b32 v100, 4, v105
  v_lshl_add_u32 v99, v100, 9, v99
  v_and_b32 v100, 7, v105
  v_lshl_add_u32 v99, v100, 28, v99
  v_and_b32 v100, 1, v1
  v_lshl_add_u32 v105, v100, 5, v105
  s_lshl_b32 s6, s5, 7
  s_add_u32 s6, s6, 162816
  v_lshl_add_u32 v105, v105, 1, s6
  s_cmp_lg_u32 s5, 0
  s_cselect_b32 s7, 0x80000000, 0
  v_or_b32 v223, s7, v99
  s_lshl_b32 s7, s5, 5
  s_add_u32 s7, s7, s9
  v_add_u32 v98, s7, v9
  v_bfe_u32 v100, v98, 2, 2
  v_lshlrev_b32 v100, 3, v100
  v_bfe_u32 v101, v98, 4, 1
  v_lshl_add_u32 v100, v101, 2, v100
  v_and_b32 v101, 3, v98
  v_add_u32 v100, v100, v101
  v_lshlrev_b32 v100, 4, v100
  v_lshrrev_b32 v101, 5, v98
  v_lshl_add_u32 v100, v101, 15, v100
  v_cmp_gt_u32 vcc, 128, v98
  v_bfrev_b32 v101, 1
  s_nop 0
  v_cndmask_b32 v222, v101, v100, vcc
  v_lshl_add_u32 v222, v7, 9, v222
  v_min_u32 v2, 2, v6
  v_lshlrev_b32 v2, 4, v2
  v_lshl_add_u32 v2, v7, 6, v2
  s_lshl_b32 s7, s5, 10
  s_add_u32 s7, s7, 156672
  v_add_u32 v122, s7, v2
  v_add_u32 v123, s92, v32
  s_mul_i32 s7, s5, 384
  s_add_u32 s7, s7, 160768
  v_lshlrev_b32 v2, 7, v6
  v_lshl_add_u32 v2, v7, 6, v2
  v_add_u32 v124, s7, v2
  v_lshrrev_b32 v2, 3, v1
  v_bfe_u32 v3, v1, 4, 1
  v_lshlrev_b32 v3, 2, v3
  v_and_b32 v4, 7, v1
  v_xor_b32 v3, v3, v4
  v_lshlrev_b32 v3, 4, v3
  v_lshl_add_u32 v197, v2, 10, v3
  s_and_b32 s28, s21, 3
  s_add_u32 s7, s5, s28
  s_and_b32 s7, s7, 3
  s_lshl_b32 s7, s7, 16
  s_lshl_b32 s6, s21, 7
  s_add_u32 s7, s7, s6
  v_add_u32 v197, s7, v197
  s_lshl_b32 s28, s28, 12
  s_and_b32 s8, s4, 1
  s_lshl_b32 s8, s8, 1
  s_bfe_u32 s6, s3, 0x10001
  s_add_u32 s8, s8, s6
  s_lshr_b32 s29, s3, 2
  s_lshl_b32 s29, s29, 1
  s_and_b32 s6, s3, 1
  s_add_u32 s29, s29, s6
  s_lshr_b32 s9, s4, 1
  v_and_b32 v2, 3, v1
  v_bfe_u32 v3, v1, 2, 1
  v_lshl_add_u32 v2, v3, 3, v2
  v_lshlrev_b32 v2, 10, v2
  v_lshrrev_b32 v3, 3, v1
  v_lshl_add_u32 v2, v3, 4, v2
  s_lshl_b32 s6, s9, 16
  s_and_b32 s7, s29, 1
  s_lshl_b32 s7, s7, 15
  s_add_u32 s6, s6, s7
  s_lshl_b32 s7, s8, 8
  s_add_u32 s6, s6, s7
  s_lshl_b32 s7, s22, 12
  s_add_u32 s6, s6, s7
  s_and_b32 s7, s29, 4
  s_lshl_b32 s7, s7, 5
  s_add_u32 s6, s6, s7
  s_lshl_b32 s7, s23, 14
  s_add_u32 s6, s6, s7
  v_add_u32 v192, s6, v2
  s_mul_i32 s6, s8, 448
  s_lshr_b32 s7, s29, 1
  s_mul_i32 s7, s7, 112
  s_add_u32 s6, s6, s7
  s_lshl_b32 s7, s5, 5
  s_add_u32 s6, s6, s7
  s_lshl_b32 s6, s6, 10
  s_lshl_b32 s7, s9, 7
  s_add_u32 s6, s6, s7
  s_and_b32 s7, s29, 1
  s_lshl_b32 s7, s7, 13
  s_add_u32 s6, s6, s7
  v_mul_u32_u24 v3, 896, v3
  v_add3_u32 v193, s6, v3, v8
  s_lshl_b32 s6, s9, 2
  s_add_u32 s6, s6, s8
  s_mul_i32 s13, s6, 90112
  s_add_u32 s13, s13, 22020096
  s_lshl_b32 s6, s6, 3
  s_add_u32 s6, s6, s29
  s_lshl_b32 s6, s6, 7
  s_add_u32 s30, s6, 21757952
  s_lshl_b32 s6, s5, 2
  s_add_u32 s30, s30, s6
  s_and_b32 s6, s29, 4
  s_lshl_b32 s6, s6, 2
  s_and_b32 s7, s29, 2
  s_lshl_b32 s7, s7, 1
  s_add_u32 s6, s6, s7
  s_and_b32 s7, s29, 1
  s_add_u32 s6, s6, s7
  s_lshl_b32 s6, s6, 10
  s_lshl_b32 s7, s5, 7
  s_add_u32 s6, s6, s7
  s_add_u32 s6, s6, s13
  v_and_b32 v2, 7, v1
  v_lshl_add_u32 v2, v2, 4, s6
  v_lshl_add_u32 v2, v7, 13, v2
  v_bfe_u32 v3, v1, 4, 1
  v_lshl_add_u32 v2, v3, 11, v2
  v_bfe_u32 v3, v1, 3, 1
  v_lshl_add_u32 v194, v3, 9, v2
  s_lshr_b32 s6, s29, 1
  s_lshl_b32 s7, s6, 2
  s_mul_i32 s6, s6, 3
  s_add_u32 s6, s6, 12
  s_cmp_lt_u32 s5, 2
  s_cselect_b32 s6, s7, s6
  s_lshl_b32 s7, s5, 1
  s_add_u32 s6, s6, s7
  s_lshl_b32 s6, s6, 2
  s_and_b32 s7, s29, 1
  s_add_u32 s6, s6, s7
  s_add_u32 s6, s6, 64
  s_lshl_b32 s6, s6, 9
  s_add_u32 s6, s6, s13
  v_lshl_add_u32 v2, v7, 9, v8
  v_add_u32 v195, s6, v2
  s_add_u32 m0, s92, 65536
  s_add_u32 s13, s94, 0
  buffer_load_dwordx4 v20, s[72:75], s13 offen lds
  s_lshl_b32 s8, s12, 1
  s_add_u32 s8, s8, s23
  s_lshl_b32 s6, s3, 2
  s_add_u32 s6, s6, s8
  s_lshl_b32 s6, s6, 15
  s_lshl_b32 s7, s21, 7
  s_add_u32 s6, s6, s7
  s_lshl_b32 s7, s22, 6
  s_add_u32 s6, s6, s7
  v_lshlrev_b32 v2, 10, v9
  v_lshl_add_u32 v2, v7, 4, v2
  v_add_u32 v34, s6, v2
  s_lshl_b32 s6, s8, 8
  s_add_u32 s6, s6, 158720
  v_lshl_add_u32 v196, v9, 2, s6
  s_lshl_b32 s6, s8, 15
  s_add_u32 s6, s6, s16
  s_lshl_b32 s7, s22, 14
  s_add_u32 s7, s6, s7
  s_add_u32 s7, s7, 131072
  v_add_u32 v33, s7, v8
  s_lshl_b32 s7, s21, 12
  s_add_u32 s6, s6, s7
  s_lshl_b32 s7, s22, 11
  s_add_u32 s6, s6, s7
  s_add_u32 s31, s6, 262144
  s_lshl_b32 s6, s8, 12
  s_lshl_b32 s7, s21, 9
  s_add_u32 s6, s6, s7
  s_lshl_b32 s7, s22, 3
  s_add_u32 s6, s6, s7
  s_add_u32 s6, s6, s16
  s_add_u32 s36, s6, 1118208
  s_add_u32 m0, s92, 66560
  s_add_u32 s13, s94, 16384
  buffer_load_dwordx4 v20, s[72:75], s13 offen lds
  s_waitcnt vmcnt(15)
  v_dot2_f32_bf16 v36, v248, v18, 0
  ds_write_b128 v29, v[248:251]
  v_dot2_f32_bf16 v37, v248, v248, 0
  s_add_u32 m0, s92, 67584
  s_add_u32 s13, s94, 32768
  buffer_load_dwordx4 v20, s[72:75], s13 offen lds
  v_dot2_f32_bf16 v38, v249, v18, 0
  v_dot2_f32_bf16 v39, v249, v249, 0
  v_dot2_f32_bf16 v36, v250, v18, v36
  v_dot2_f32_bf16 v37, v250, v250, v37
  v_dot2_f32_bf16 v38, v251, v18, v38
  v_dot2_f32_bf16 v39, v251, v251, v39
  s_nop 1
  v_add_f32 v36, v36, v38
  v_add_f32 v37, v37, v39
  s_add_u32 m0, s92, 68608
  s_add_u32 s13, s94, 49152
  buffer_load_dwordx4 v20, s[72:75], s13 offen lds
  v_add_f32_dpp v36, v36, v36 row_ror:8 row_mask:0xf bank_mask:0xf
  v_add_f32_dpp v37, v37, v37 row_ror:8 row_mask:0xf bank_mask:0xf
  s_nop 0
  v_add_f32_dpp v36, v36, v36 row_ror:4 row_mask:0xf bank_mask:0xf
  v_add_f32_dpp v37, v37, v37 row_ror:4 row_mask:0xf bank_mask:0xf
  s_nop 0
  v_add_f32_dpp v36, v36, v36 row_ror:2 row_mask:0xf bank_mask:0xf
  v_add_f32_dpp v37, v37, v37 row_ror:2 row_mask:0xf bank_mask:0xf
  v_mov_b32 v38, v36
  v_mov_b32 v39, v37
  s_add_u32 m0, s92, 69632
  s_add_u32 s13, s11, 0
  buffer_load_dwordx4 v20, s[72:75], s13 offen lds
  v_permlane16_swap_b32 v36, v38
  v_permlane16_swap_b32 v37, v39
  v_add_f32 v36, v36, v38
  v_add_f32 v37, v37, v39
  s_lshl_b32 s6, s5, 4
  v_add_u32 v2, s6, v109
  s_mov_b64 exec, 3
  ds_write_b64 v2, v[36:37]
  s_mov_b64 exec, -1
  s_add_u32 m0, s92, 70656
  s_add_u32 s13, s11, 16384
  buffer_load_dwordx4 v20, s[72:75], s13 offen lds
  s_waitcnt vmcnt(15)
  ds_read_b128 a[0:3], v176 offset:0
  ds_read_b128 a[4:7], v177 offset:0
  ds_read_b128 a[8:11], v178 offset:0
  ds_read_b128 a[12:15], v179 offset:0
  s_waitcnt lgkmcnt(3)
  v_mfma_f32_16x16x32_bf16 v[208:211], v[224:227], a[0:3], 0
  s_waitcnt lgkmcnt(2)
  v_mfma_f32_16x16x32_bf16 v[208:211], v[224:227], a[4:7], v[208:211]
  s_add_u32 m0, s92, 71680
  s_add_u32 s13, s11, 32768
  buffer_load_dwordx4 v20, s[72:75], s13 offen lds
  s_waitcnt lgkmcnt(1)
  v_mfma_f32_16x16x32_bf16 v[208:211], v[224:227], a[8:11], v[208:211]
  s_waitcnt lgkmcnt(0)
  v_mfma_f32_16x16x32_bf16 v[208:211], v[224:227], a[12:15], v[208:211]
  v_mfma_f32_4x4x4_16b_bf16 v[212:215], a[0:1], a[0:1], 0
  s_add_u32 m0, s92, 72704
  s_add_u32 s13, s11, 49152
  buffer_load_dwordx4 v20, s[72:75], s13 offen lds
  v_mfma_f32_4x4x4_16b_bf16 v[216:219], a[2:3], a[2:3], 0
  v_mfma_f32_4x4x4_16b_bf16 v[212:215], a[4:5], a[4:5], v[212:215]
  s_nop 0
  v_mfma_f32_4x4x4_16b_bf16 v[216:219], a[6:7], a[6:7], v[216:219]
  v_mfma_f32_4x4x4_16b_bf16 v[212:215], a[8:9], a[8:9], v[212:215]
  s_nop 0
  v_mfma_f32_4x4x4_16b_bf16 v[216:219], a[10:11], a[10:11], v[216:219]
  s_add_u32 m0, s92, 0
  s_add_u32 s10, s10, 128
  s_and_b32 s10, s10, 1023
  buffer_load_dwordx4 v19, s[52:55], s10 offen offset:0 lds
  v_mfma_f32_4x4x4_16b_bf16 v[212:215], a[12:13], a[12:13], v[212:215]
  v_mfma_f32_4x4x4_16b_bf16 v[216:219], a[14:15], a[14:15], v[216:219]
  buffer_load_dwordx4 v21, s[52:55], s10 offen offset:1024 lds
  buffer_load_dwordx4 v22, s[52:55], s10 offen offset:2048 lds
  buffer_load_dwordx4 v23, s[52:55], s10 offen offset:3072 lds
  s_add_u32 m0, s92, 4096
  s_add_u32 s10, s10, 128
  s_and_b32 s10, s10, 1023
  buffer_load_dwordx4 v19, s[52:55], s10 offen offset:0 lds
  buffer_load_dwordx4 v21, s[52:55], s10 offen offset:1024 lds
  buffer_load_dwordx4 v22, s[52:55], s10 offen offset:2048 lds
  buffer_load_dwordx4 v23, s[52:55], s10 offen offset:3072 lds
  s_add_u32 m0, s92, 32768
  s_add_u32 s10, s10, 128
  s_and_b32 s10, s10, 1023
  buffer_load_dwordx4 v19, s[52:55], s10 offen offset:0 lds
  buffer_load_dwordx4 v21, s[52:55], s10 offen offset:1024 lds
  buffer_load_dwordx4 v22, s[52:55], s10 offen offset:2048 lds
  buffer_load_dwordx4 v23, s[52:55], s10 offen offset:3072 lds
  s_waitcnt vmcnt(12)
  s_barrier
  s_mov_b32 s38, 0xaaaaaaaa
  s_mov_b32 s39, 0xaaaaaaaa
  s_mov_b32 s40, 0xcccccccc
  s_mov_b32 s41, 0xcccccccc
  ds_read_b64_tr_b16 a[192:193], v32 offset:0
  ds_read_b64_tr_b16 a[194:195], v32 offset:256
  ds_read_b64_tr_b16 a[196:197], v32 offset:1024
  ds_read_b64_tr_b16 a[198:199], v32 offset:1280
  s_add_u32 m0, s92, 36864
  s_add_u32 s10, s10, 128
  s_and_b32 s10, s10, 1023
  buffer_load_dwordx4 v19, s[52:55], s10 offen offset:0 lds
  ds_read_b64_tr_b16 a[200:201], v32 offset:2048
  ds_read_b64_tr_b16 a[202:203], v32 offset:2304
  ds_read_b64_tr_b16 a[204:205], v32 offset:3072
  ds_read_b64_tr_b16 a[206:207], v32 offset:3328
  ds_read_b64_tr_b16 a[208:209], v32 offset:4096
  ds_read_b64_tr_b16 a[210:211], v32 offset:4352
  ds_read_b64_tr_b16 a[212:213], v32 offset:5120
  ds_read_b64_tr_b16 a[214:215], v32 offset:5376
  ds_read_b64_tr_b16 a[128:129], v123 offset:0
  ds_read_b64_tr_b16 a[130:131], v123 offset:256
  ds_read_b128 a[132:135], v122 offset:0
  buffer_load_dwordx4 v21, s[52:55], s10 offen offset:1024 lds
  ds_read_b64_tr_b16 a[136:137], v123 offset:1024
  ds_read_b64_tr_b16 a[138:139], v123 offset:1280
  ds_read_b128 a[140:143], v122 offset:128
  ds_read_b64_tr_b16 a[216:217], v32 offset:6144
  ds_read_b64_tr_b16 a[218:219], v32 offset:6400
  v_mfma_f32_32x32x16_bf16 v[64:79], a[192:195], a[0:3], 0
  ds_read_b64_tr_b16 a[144:145], v123 offset:2048
  ds_read_b64_tr_b16 a[146:147], v123 offset:2304
  ds_read_b128 a[148:151], v122 offset:256
  buffer_load_dwordx4 v22, s[52:55], s10 offen offset:2048 lds
  s_waitcnt lgkmcnt(8)
  v_mfma_f32_32x32x16_bf16 v[128:143], a[128:131], a[132:135], 0
  s_waitcnt vmcnt(11)
  ds_read_b128 a[16:19], v152 offset:0
  ds_read_b128 a[20:23], v153 offset:0
  ds_read_b128 a[24:27], v154 offset:0
  ds_read_b128 a[28:31], v155 offset:0
  ds_read_b64_tr_b16 a[220:221], v32 offset:7168
  buffer_load_dwordx4 v23, s[52:55], s10 offen offset:3072 lds
  ds_read_b64_tr_b16 a[222:223], v32 offset:7424
  v_mfma_f32_32x32x16_bf16 v[64:79], a[196:199], a[4:7], v[64:79]
  ds_read_b64_tr_b16 a[152:153], v123 offset:3072
  ds_read_b64_tr_b16 a[154:155], v123 offset:3328
  ds_read_b128 a[156:159], v122 offset:384
  s_waitcnt lgkmcnt(14)
  v_mfma_f32_32x32x16_bf16 v[128:143], a[136:139], a[140:143], v[128:143]
  ds_read_b64_tr_b16 a[224:225], v32 offset:8192
  s_add_u32 m0, s15, 0
  s_add_u32 s10, s10, 128
  s_and_b32 s10, s10, 1023
  buffer_load_dwordx4 v19, s[52:55], s10 offen offset:0 lds
  ds_read_b64_tr_b16 a[226:227], v32 offset:8448
  v_mfma_f32_32x32x16_bf16 v[64:79], a[200:203], a[8:11], v[64:79]
  ds_read_b64_tr_b16 a[160:161], v123 offset:4096
  ds_read_b64_tr_b16 a[162:163], v123 offset:4352
  ds_read_b128 a[164:167], v122 offset:512
  s_waitcnt lgkmcnt(14)
  v_mfma_f32_32x32x16_bf16 v[128:143], a[144:147], a[148:151], v[128:143]
  ds_read_b64_tr_b16 a[228:229], v32 offset:9216
  buffer_load_dwordx4 v21, s[52:55], s10 offen offset:1024 lds
  ds_read_b64_tr_b16 a[230:231], v32 offset:9472
  v_mfma_f32_32x32x16_bf16 v[64:79], a[204:207], a[12:15], v[64:79]
  ds_read_b64_tr_b16 a[168:169], v123 offset:5120
  ds_read_b64_tr_b16 a[170:171], v123 offset:5376
  ds_read_b128 a[172:175], v122 offset:640
  s_waitcnt lgkmcnt(10)
  v_mfma_f32_32x32x16_bf16 v[128:143], a[152:155], a[156:159], v[128:143]
  buffer_load_dwordx4 v22, s[52:55], s10 offen offset:2048 lds
  v_mfma_f32_16x16x32_bf16 v[208:211], v[224:227], a[16:19], v[208:211]
  v_mfma_f32_16x16x32_bf16 v[208:211], v[224:227], a[20:23], v[208:211]
  buffer_load_dwordx4 v23, s[52:55], s10 offen offset:3072 lds
  v_mfma_f32_16x16x32_bf16 v[208:211], v[224:227], a[24:27], v[208:211]
  v_mfma_f32_16x16x32_bf16 v[208:211], v[224:227], a[28:31], v[208:211]
  v_mfma_f32_4x4x4_16b_bf16 v[212:215], a[16:17], a[16:17], v[212:215]
L_stub0:
  s_cbranch_execz L_stub4
  s_add_u32 m0, s15, 4096
  s_add_u32 s10, s10, 128
  s_and_b32 s10, s10, 1023
  buffer_load_dwordx4 v19, s[52:55], s10 offen offset:0 lds
  v_mfma_f32_4x4x4_16b_bf16 v[216:219], a[18:19], a[18:19], v[216:219]
  v_mfma_f32_4x4x4_16b_bf16 v[212:215], a[20:21], a[20:21], v[212:215]
  s_nop 0
  v_mfma_f32_4x4x4_16b_bf16 v[216:219], a[22:23], a[22:23], v[216:219]
  v_mfma_f32_4x4x4_16b_bf16 v[212:215], a[24:25], a[24:25], v[212:215]
  s_nop 0
  v_mfma_f32_4x4x4_16b_bf16 v[216:219], a[26:27], a[26:27], v[216:219]
  buffer_load_dwordx4 v21, s[52:55], s10 offen offset:1024 lds
  v_mfma_f32_4x4x4_16b_bf16 v[212:215], a[28:29], a[28:29], v[212:215]
  v_mfma_f32_4x4x4_16b_bf16 v[216:219], a[30:31], a[30:31], v[216:219]
  s_waitcnt vmcnt(14)
  ds_read_b128 a[32:35], v152 offset:4096
  ds_read_b128 a[36:39], v153 offset:4096
  ds_read_b128 a[40:43], v154 offset:4096
  ds_read_b128 a[44:47], v155 offset:4096
  ds_read_b64_tr_b16 a[232:233], v32 offset:10240
  ds_read_b64_tr_b16 a[234:235], v32 offset:10496
  buffer_load_dwordx4 v22, s[52:55], s10 offen offset:2048 lds
  v_mfma_f32_32x32x16_bf16 v[64:79], a[208:211], a[16:19], v[64:79]
  ds_read_b64_tr_b16 a[176:177], v123 offset:6144
  ds_read_b64_tr_b16 a[178:179], v123 offset:6400
  ds_read_b128 a[180:183], v122 offset:768
  s_waitcnt lgkmcnt(14)
  v_mfma_f32_32x32x16_bf16 v[128:143], a[160:163], a[164:167], v[128:143]
  ds_read_b64_tr_b16 a[236:237], v32 offset:11264
  buffer_load_dwordx4 v23, s[52:55], s10 offen offset:3072 lds
  ds_read_b64_tr_b16 a[238:239], v32 offset:11520
  v_mfma_f32_32x32x16_bf16 v[64:79], a[212:215], a[20:23], v[64:79]
  ds_read_b64_tr_b16 a[184:185], v123 offset:7168
  ds_read_b64_tr_b16 a[186:187], v123 offset:7424
  ds_read_b128 a[188:191], v122 offset:896
  s_waitcnt lgkmcnt(14)
  v_mfma_f32_32x32x16_bf16 v[128:143], a[168:171], a[172:175], v[128:143]
  ds_read_b64_tr_b16 a[192:193], v32 offset:12288
  s_mov_b32 m0, s14
  s_add_u32 s10, s10, 128
  s_and_b32 s10, s10, 1023
  buffer_load_dwordx4 v19, s[52:55], s10 offen offset:0 lds
  ds_read_b64_tr_b16 a[194:195], v32 offset:12544
  v_mfma_f32_32x32x16_bf16 v[64:79], a[216:219], a[24:27], v[64:79]
  s_waitcnt lgkmcnt(7)
  v_mfma_f32_32x32x16_bf16 v[128:143], a[176:179], a[180:183], v[128:143]
  buffer_load_dwordx4 v21, s[52:55], s10 offen offset:1024 lds
  v_mfma_f32_16x16x32_bf16 v[208:211], v[224:227], a[32:35], v[208:211]
  v_mfma_f32_16x16x32_bf16 v[208:211], v[224:227], a[36:39], v[208:211]
  buffer_load_dwordx4 v22, s[52:55], s10 offen offset:2048 lds
  v_mfma_f32_16x16x32_bf16 v[208:211], v[224:227], a[40:43], v[208:211]
  v_mfma_f32_16x16x32_bf16 v[208:211], v[224:227], a[44:47], v[208:211]
  v_mfma_f32_4x4x4_16b_bf16 v[212:215], a[32:33], a[32:33], v[212:215]
  buffer_load_dwordx4 v23, s[52:55], s10 offen offset:3072 lds
  v_mfma_f32_4x4x4_16b_bf16 v[216:219], a[34:35], a[34:35], v[216:219]
  v_mfma_f32_4x4x4_16b_bf16 v[212:215], a[36:37], a[36:37], v[212:215]
  s_nop 0
  v_mfma_f32_4x4x4_16b_bf16 v[216:219], a[38:39], a[38:39], v[216:219]
  v_mfma_f32_4x4x4_16b_bf16 v[212:215], a[40:41], a[40:41], v[212:215]
  s_nop 0
  v_mfma_f32_4x4x4_16b_bf16 v[216:219], a[42:43], a[42:43], v[216:219]
  buffer_load_dword v30, v31, s[88:91], 0 offen sc1
  v_mfma_f32_4x4x4_16b_bf16 v[212:215], a[44:45], a[44:45], v[212:215]
  v_mfma_f32_4x4x4_16b_bf16 v[216:219], a[46:47], a[46:47], v[216:219]
  s_waitcnt vmcnt(17)
  ds_read_b128 a[48:51], v152 offset:32768
  ds_read_b128 a[52:55], v153 offset:32768
  ds_read_b128 a[56:59], v154 offset:32768
  ds_read_b128 a[60:63], v155 offset:32768
  ds_read_b64_tr_b16 a[196:197], v32 offset:13312
  ds_read_b64_tr_b16 a[198:199], v32 offset:13568
  s_mov_b32 m0, 156416
  s_mov_b64 exec, 0xff
  s_bitcmp1_b32 s29, 1
  s_cbranch_scc1 L_cim2
  buffer_load_dword v192, s[64:67], 0 offen lds
  s_branch L_cdone2
L_cim2:
  buffer_load_dword v192, s[68:71], 0 offen lds
L_cdone2:
  s_mov_b64 exec, -1
  v_mfma_f32_32x32x16_bf16 v[64:79], a[220:223], a[28:31], v[64:79]
  s_waitcnt lgkmcnt(8)
  v_mfma_f32_32x32x16_bf16 v[128:143], a[184:187], a[188:191], v[128:143]
  ds_read_b64_tr_b16 a[200:201], v32 offset:14336
  s_mov_b32 m0, 156416
  s_mov_b32 exec_lo, 0x01010101
  s_mov_b32 exec_hi, 0x01010101
  s_movk_i32 s13, 0
  buffer_load_dword v193, s[84:87], s13 offen lds
  s_mov_b64 exec, -1
  ds_read_b64_tr_b16 a[202:203], v32 offset:14592
  v_mfma_f32_32x32x16_bf16 v[64:79], a[224:227], a[32:35], v[64:79]
  ds_read_b64_tr_b16 a[204:205], v32 offset:15360
  ds_read_b64_tr_b16 a[206:207], v32 offset:15616
  v_mfma_f32_32x32x16_bf16 v[64:79], a[228:231], a[36:39], v[64:79]
  s_mov_b32 m0, 156416
  s_mov_b32 exec_lo, 0x01010101
  s_mov_b32 exec_hi, 0x01010101
  s_movk_i32 s13, 16384
  buffer_load_dword v193, s[84:87], s13 offen lds
  s_mov_b64 exec, -1
  s_waitcnt lgkmcnt(9)
  v_mfma_f32_16x16x32_bf16 v[208:211], v[224:227], a[48:51], v[208:211]
  s_waitcnt lgkmcnt(8)
  v_mfma_f32_16x16x32_bf16 v[208:211], v[224:227], a[52:55], v[208:211]
  s_waitcnt lgkmcnt(7)
  v_mfma_f32_16x16x32_bf16 v[208:211], v[224:227], a[56:59], v[208:211]
  s_and_b32 s13, s93, 63
  s_mul_i32 s13, s13, 8192
  s_bitcmp1_b32 s93, 6
  s_cselect_b32 s13, 0x80000000, s13
  s_mov_b32 m0, 156416
  s_nop 0
  buffer_load_dword v0, s[56:59], s13 offen offset:0 lds
  s_waitcnt lgkmcnt(6)
  v_mfma_f32_16x16x32_bf16 v[208:211], v[224:227], a[60:63], v[208:211]
  v_mfma_f32_4x4x4_16b_bf16 v[212:215], a[48:49], a[48:49], v[212:215]
  v_mfma_f32_4x4x4_16b_bf16 v[216:219], a[50:51], a[50:51], v[216:219]
  s_nop 0
  v_mfma_f32_4x4x4_16b_bf16 v[212:215], a[52:53], a[52:53], v[212:215]
  s_and_b32 s13, s93, 63
  s_mul_i32 s13, s13, 8192
  s_bitcmp0_b32 s93, 6
  s_cselect_b32 s13, 0x80000000, s13
  s_mov_b32 m0, 156416
  s_nop 0
  buffer_load_dword v0, s[76:79], s13 offen offset:0 lds
  v_mfma_f32_4x4x4_16b_bf16 v[216:219], a[54:55], a[54:55], v[216:219]
  v_mfma_f32_4x4x4_16b_bf16 v[212:215], a[56:57], a[56:57], v[212:215]
  s_nop 0
  v_mfma_f32_4x4x4_16b_bf16 v[216:219], a[58:59], a[58:59], v[216:219]
  v_mfma_f32_4x4x4_16b_bf16 v[212:215], a[60:61], a[60:61], v[212:215]
  s_nop 0
  v_mfma_f32_4x4x4_16b_bf16 v[216:219], a[62:63], a[62:63], v[216:219]
  s_waitcnt vmcnt(18)
  s_and_b32 s13, s93, 63
  s_mul_i32 s13, s13, 8192
  s_bitcmp0_b32 s93, 6
  s_cselect_b32 s13, 0x80000000, s13
  s_mov_b32 m0, 156416
  s_nop 0
  buffer_load_dword v0, s[60:63], s13 offen offset:0 lds
  ds_read_b128 a[64:67], v152 offset:36864
  ds_read_b128 a[68:71], v153 offset:36864
  ds_read_b128 a[72:75], v154 offset:36864
  ds_read_b128 a[76:79], v155 offset:36864
  ds_read_b64_tr_b16 a[208:209], v32 offset:16384
  ds_read_b64_tr_b16 a[210:211], v32 offset:16640
  v_mfma_f32_32x32x16_bf16 v[64:79], a[232:235], a[40:43], v[64:79]
  ds_read_b64_tr_b16 a[212:213], v32 offset:17408
  s_and_b32 s13, s2, 7
  s_lshl_b32 s13, s13, 7
  s_add_u32 s13, s13, s93
  s_mul_i32 s13, s13, 1792
  s_mov_b32 m0, 156416
  s_mov_b64 exec, 16383
  buffer_load_dword v0, s[80:83], s13 offen lds
  s_mov_b64 exec, -1
  ds_read_b64_tr_b16 a[214:215], v32 offset:17664
  v_mfma_f32_32x32x16_bf16 v[64:79], a[236:239], a[44:47], v[64:79]
  ds_read_b64_tr_b16 a[216:217], v32 offset:18432
  ds_read_b64_tr_b16 a[218:219], v32 offset:18688
  v_mfma_f32_32x32x16_bf16 v[64:79], a[192:195], a[48:51], v[64:79]
  s_mov_b32 exec_lo, 7
  s_mov_b32 exec_hi, 7
  ds_write_b128 v124, v[128:131] offset:0
  ds_write_b128 v124, v[132:135] offset:16
  ds_write_b128 v124, v[136:139] offset:32
  ds_write_b128 v124, v[140:143] offset:48
  s_mov_b64 exec, -1
  s_waitcnt lgkmcnt(13)
  v_mfma_f32_16x16x32_bf16 v[208:211], v[224:227], a[64:67], v[208:211]
  s_waitcnt lgkmcnt(12)
  v_mfma_f32_16x16x32_bf16 v[208:211], v[224:227], a[68:71], v[208:211]
  s_waitcnt lgkmcnt(11)
  v_mfma_f32_16x16x32_bf16 v[208:211], v[224:227], a[72:75], v[208:211]
  s_waitcnt lgkmcnt(10)
  v_mfma_f32_16x16x32_bf16 v[208:211], v[224:227], a[76:79], v[208:211]
  v_mfma_f32_4x4x4_16b_bf16 v[212:215], a[64:65], a[64:65], v[212:215]
  v_mfma_f32_4x4x4_16b_bf16 v[216:219], a[66:67], a[66:67], v[216:219]
  s_nop 0
  v_mfma_f32_4x4x4_16b_bf16 v[212:215], a[68:69], a[68:69], v[212:215]
  v_mfma_f32_4x4x4_16b_bf16 v[216:219], a[70:71], a[70:71], v[216:219]
  s_nop 0
  v_mfma_f32_4x4x4_16b_bf16 v[212:215], a[72:73], a[72:73], v[212:215]
  v_mfma_f32_4x4x4_16b_bf16 v[216:219], a[74:75], a[74:75], v[216:219]
  s_nop 0
  v_mfma_f32_4x4x4_16b_bf16 v[212:215], a[76:77], a[76:77], v[212:215]
  v_mfma_f32_4x4x4_16b_bf16 v[216:219], a[78:79], a[78:79], v[216:219]
  s_waitcnt vmcnt(16)
  ds_read_b128 a[80:83], v156 offset:0
  ds_read_b128 a[84:87], v157 offset:0
  ds_read_b128 a[88:91], v158 offset:0
  ds_read_b128 a[92:95], v159 offset:0
  ds_read_b64_tr_b16 a[220:221], v32 offset:19456
  ds_read_b64_tr_b16 a[222:223], v32 offset:19712
  v_mfma_f32_32x32x16_bf16 v[64:79], a[196:199], a[52:55], v[64:79]
  ds_read_b64_tr_b16 a[224:225], v32 offset:20480
  ds_read_b64_tr_b16 a[226:227], v32 offset:20736
  v_mfma_f32_32x32x16_bf16 v[64:79], a[200:203], a[56:59], v[64:79]
  s_waitcnt lgkmcnt(8)
  s_barrier
  ds_read_b64_tr_b16 a[228:229], v32 offset:21504
  ds_read_b64_tr_b16 a[230:231], v32 offset:21760
  v_mfma_f32_32x32x16_bf16 v[64:79], a[204:207], a[60:63], v[64:79]
  s_add_u32 s24, s16, 1146880
  s_lshl_b32 s25, s4, 4
  s_lshl_b32 s6, s5, 2
  s_add_u32 s25, s25, s6
  s_add_u32 s25, s25, s24
  ds_read_b32 v96, v104 offset:0
  s_waitcnt lgkmcnt(10)
  v_mfma_f32_16x16x32_bf16 v[208:211], v[224:227], a[80:83], v[208:211]
  ds_read_b32 v100, v107 offset:0
  ds_read_b64 v[144:145], v109 offset:0
  s_waitcnt lgkmcnt(11)
  v_mfma_f32_16x16x32_bf16 v[208:211], v[224:227], a[84:87], v[208:211]
  ds_read_b32 v97, v104 offset:384
  ds_read_b32 v101, v107 offset:384
  s_waitcnt lgkmcnt(12)
  v_mfma_f32_16x16x32_bf16 v[208:211], v[224:227], a[88:91], v[208:211]
  ds_read_b64 v[146:147], v109 offset:16
  ds_read_b32 v98, v104 offset:768
  s_waitcnt lgkmcnt(13)
  v_mfma_f32_16x16x32_bf16 v[208:211], v[224:227], a[92:95], v[208:211]
  ds_read_b32 v102, v107 offset:768
  ds_read_b64 v[148:149], v109 offset:32
  v_mfma_f32_4x4x4_16b_bf16 v[212:215], a[80:81], a[80:81], v[212:215]
  ds_read_b32 v99, v104 offset:1152
  v_mfma_f32_4x4x4_16b_bf16 v[216:219], a[82:83], a[82:83], v[216:219]
  ds_read_b32 v103, v107 offset:1152
  v_mfma_f32_4x4x4_16b_bf16 v[212:215], a[84:85], a[84:85], v[212:215]
  ds_read_b64 v[150:151], v109 offset:48
  v_mfma_f32_4x4x4_16b_bf16 v[216:219], a[86:87], a[86:87], v[216:219]
  s_waitcnt lgkmcnt(8)
  v_add_f32 v96, v96, v97
  v_mfma_f32_4x4x4_16b_bf16 v[212:215], a[88:89], a[88:89], v[212:215]
  s_waitcnt lgkmcnt(2)
  v_add_f32 v98, v98, v99
  v_mfma_f32_4x4x4_16b_bf16 v[216:219], a[90:91], a[90:91], v[216:219]
  v_add_f32 v100, v100, v101
  v_mfma_f32_4x4x4_16b_bf16 v[212:215], a[92:93], a[92:93], v[212:215]
  s_waitcnt lgkmcnt(1)
  v_add_f32 v102, v102, v103
  v_mfma_f32_4x4x4_16b_bf16 v[216:219], a[94:95], a[94:95], v[216:219]
  s_waitcnt vmcnt(12)
  ds_read_b128 a[96:99], v156 offset:4096
  ds_read_b128 a[100:103], v157 offset:4096
  ds_read_b128 a[104:107], v158 offset:4096
  ds_read_b128 a[108:111], v159 offset:4096
  ds_read_b64_tr_b16 a[232:233], v32 offset:22528
  ds_read_b64_tr_b16 a[234:235], v32 offset:22784
  v_mfma_f32_32x32x16_bf16 v[64:79], a[208:211], a[64:67], v[64:79]
  ds_read_b64_tr_b16 a[236:237], v32 offset:23552
  ds_read_b64_tr_b16 a[238:239], v32 offset:23808
  v_add_f32 v126, v96, v98
  v_add_f32 v127, v100, v102
  ds_write_b32 v106, v127
  v_mfma_f32_32x32x16_bf16 v[64:79], a[212:215], a[68:71], v[64:79]
  ds_read_b64_tr_b16 a[192:193], v32 offset:24576
  ds_read_b64_tr_b16 a[194:195], v32 offset:24832
  ds_read_b128 v[80:83], v108 offset:0
  ds_read_b128 v[84:87], v108 offset:16
  ds_read_b128 v[88:91], v108 offset:32
  ds_read_b128 v[92:95], v108 offset:48
  v_mfma_f32_32x32x16_bf16 v[64:79], a[216:219], a[72:75], v[64:79]
  v_pk_add_f32 v[144:145], v[144:145], v[146:147]
  s_waitcnt lgkmcnt(15)
  v_pk_add_f32 v[148:149], v[148:149], v[150:151]
  v_pk_add_f32 v[144:145], v[144:145], v[148:149]
  v_mul_f32 v144, 0x3b000000, v144
  s_waitcnt lgkmcnt(14)
  v_mfma_f32_16x16x32_bf16 v[208:211], v[224:227], a[96:99], v[208:211]
  v_mul_f32 v145, 0x3b000000, v145
  v_fma_f32 v145, -v144, v144, v145
  s_waitcnt lgkmcnt(13)
  v_mfma_f32_16x16x32_bf16 v[208:211], v[224:227], a[100:103], v[208:211]
  v_max_f32 v145, 0, v145
  v_cvt_pk_bf16_f32 v172, v144, v145
  s_waitcnt lgkmcnt(12)
  v_mfma_f32_16x16x32_bf16 v[208:211], v[224:227], a[104:107], v[208:211]
  v_and_b32 v174, v10, v172
  v_add_f32 v174, 0x3727c5ac, v174
  s_waitcnt lgkmcnt(11)
  v_mfma_f32_16x16x32_bf16 v[208:211], v[224:227], a[108:111], v[208:211]
  v_cvt_pk_bf16_f32 v174, v174, v174
  v_and_b32 v174, v10, v174
  v_mfma_f32_4x4x4_16b_bf16 v[212:215], a[96:97], a[96:97], v[212:215]
  v_mfma_f32_4x4x4_16b_bf16 v[216:219], a[98:99], a[98:99], v[216:219]
  s_nop 0
  v_mfma_f32_4x4x4_16b_bf16 v[212:215], a[100:101], a[100:101], v[212:215]
  v_mfma_f32_4x4x4_16b_bf16 v[216:219], a[102:103], a[102:103], v[216:219]
  s_nop 0
  v_mfma_f32_4x4x4_16b_bf16 v[212:215], a[104:105], a[104:105], v[212:215]
  v_mfma_f32_4x4x4_16b_bf16 v[216:219], a[106:107], a[106:107], v[216:219]
  s_nop 0
  v_mfma_f32_4x4x4_16b_bf16 v[212:215], a[108:109], a[108:109], v[212:215]
  v_mfma_f32_4x4x4_16b_bf16 v[216:219], a[110:111], a[110:111], v[216:219]
  s_waitcnt vmcnt(8)
  ds_read_b128 a[112:115], v176 offset:0
  ds_read_b128 a[116:119], v177 offset:0
  ds_read_b128 a[120:123], v178 offset:0
  ds_read_b128 a[124:127], v179 offset:0
  ds_read_b64_tr_b16 a[196:197], v32 offset:25600
  ds_read_b64_tr_b16 a[198:199], v32 offset:25856
  v_mfma_f32_32x32x16_bf16 v[64:79], a[220:223], a[76:79], v[64:79]
  ds_read_b64_tr_b16 a[200:201], v32 offset:26624
  ds_read_b64_tr_b16 a[202:203], v32 offset:26880
  v_sqrt_f32 v174, v174
  v_xor_b32 v42, 0x80000000, v144
  v_cvt_pk_bf16_f32 v174, v174, v174
  v_mfma_f32_32x32x16_bf16 v[64:79], a[224:227], a[80:83], v[64:79]
  ds_read_b64_tr_b16 a[204:205], v32 offset:27648
  ds_read_b64_tr_b16 a[206:207], v32 offset:27904
  v_and_b32 v174, v10, v174
  v_rcp_f32 v173, v174
  v_lshlrev_b32 v172, 16, v172
  v_mfma_f32_32x32x16_bf16 v[64:79], a[228:231], a[84:87], v[64:79]
  v_mul_f32 v145, v145, v173
  v_mul_f32 v145, v145, v173
  v_cvt_pk_bf16_f32 v145, v145, v145
  v_and_b32 v145, v10, v145
  v_add_f32 v145, 0x3727c5ac, v145
  v_cvt_pk_bf16_f32 v145, v145, v145
  s_waitcnt lgkmcnt(9)
  v_mfma_f32_16x16x32_bf16 v[208:211], v[224:227], a[112:115], v[208:211]
  v_and_b32 v145, v10, v145
  s_waitcnt lgkmcnt(8)
  v_mfma_f32_16x16x32_bf16 v[208:211], v[224:227], a[116:119], v[208:211]
  v_sqrt_f32 v145, v145
  s_waitcnt lgkmcnt(7)
  v_mfma_f32_16x16x32_bf16 v[208:211], v[224:227], a[120:123], v[208:211]
  v_mul_f32 v175, 0xbdd2d3e8, v173
  v_cvt_pk_bf16_f32 v145, v145, v145
  s_waitcnt lgkmcnt(6)
  v_mfma_f32_16x16x32_bf16 v[208:211], v[224:227], a[124:127], v[208:211]
  v_and_b32 v145, v10, v145
  v_mul_f32 v43, v174, v145
  v_mfma_f32_4x4x4_16b_bf16 v[212:215], a[112:113], a[112:113], v[212:215]
  v_mfma_f32_4x4x4_16b_bf16 v[216:219], a[114:115], a[114:115], v[216:219]
  s_nop 0
  v_mfma_f32_4x4x4_16b_bf16 v[212:215], a[116:117], a[116:117], v[212:215]
  v_mfma_f32_4x4x4_16b_bf16 v[216:219], a[118:119], a[118:119], v[216:219]
  s_nop 0
  v_mfma_f32_4x4x4_16b_bf16 v[212:215], a[120:121], a[120:121], v[212:215]
  v_mfma_f32_4x4x4_16b_bf16 v[216:219], a[122:123], a[122:123], v[216:219]
  s_nop 0
  v_mfma_f32_4x4x4_16b_bf16 v[212:215], a[124:125], a[124:125], v[212:215]
  v_mfma_f32_4x4x4_16b_bf16 v[216:219], a[126:127], a[126:127], v[216:219]
  ds_read_b64_tr_b16 a[208:209], v32 offset:28672
  ds_read_b64_tr_b16 a[210:211], v32 offset:28928
  v_mfma_f32_32x32x16_bf16 v[64:79], a[232:235], a[88:91], v[64:79]
  ds_read_b64_tr_b16 a[212:213], v32 offset:29696
  ds_read_b64_tr_b16 a[214:215], v32 offset:29952
  v_rcp_f32 v145, v145
  v_mul_f32 v175, v175, v173
  v_mul_f32 v144, v145, v173
  v_mfma_f32_32x32x16_bf16 v[64:79], a[236:239], a[92:95], v[64:79]
  ds_read_b64_tr_b16 a[216:217], v32 offset:30720
  ds_read_b64_tr_b16 a[218:219], v32 offset:30976
  v_mul_f32 v175, v175, v145
  v_mul_f32 v40, 0xc0135761, v144
  v_mul_f32 v175, v175, v145
  v_mul_f32 v41, v175, v144
  v_mfma_f32_32x32x16_bf16 v[64:79], a[192:195], a[96:99], v[64:79]
  ds_read_b64_tr_b16 a[220:221], v32 offset:31744
  ds_read_b64_tr_b16 a[222:223], v32 offset:32000
  v_fmac_f32 v126, v42, v127
  v_mul_f32 v127, v126, v126
  v_fma_f32 v127, v127, v41, v40
  v_mul_f32 v127, v127, v126
  s_waitcnt lgkmcnt(12)
  v_mfma_f32_32x32x16_bf16 v[64:79], a[196:199], a[100:103], v[64:79]
  v_exp_f32 v127, v127
  s_nop 0
  v_fma_f32 v127, v127, v43, v43
  v_rcp_f32 v127, v127
  s_waitcnt lgkmcnt(10)
  v_mfma_f32_32x32x16_bf16 v[64:79], a[200:203], a[104:107], v[64:79]
  v_mul_f32 v127, v127, v126
  v_cvt_pk_bf16_f32 v127, v127, v127
  v_and_b32 v127, s26, v127
  ds_write_b16 v105, v127
  s_waitcnt lgkmcnt(9)
  v_mfma_f32_32x32x16_bf16 v[64:79], a[204:207], a[108:111], v[64:79]
  v_and_b32 v100, -16, v105
  ds_read_b128 v[96:99], v100
  v_pk_add_f32 v[212:213], v[212:213], v[216:217]
  v_pk_add_f32 v[214:215], v[214:215], v[218:219]
  v_cndmask_b32 v212, v212, v213, s[38:39]
  s_waitcnt lgkmcnt(8)
  v_mfma_f32_32x32x16_bf16 v[64:79], a[208:211], a[112:115], v[64:79]
  v_cndmask_b32 v214, v214, v215, s[38:39]
  v_cndmask_b32 v212, v212, v214, s[40:41]
  v_mov_b32 v213, v212
  s_nop 1
  v_permlane32_swap_b32 v212, v213
  s_waitcnt lgkmcnt(6)
  v_mfma_f32_32x32x16_bf16 v[64:79], a[212:215], a[116:119], v[64:79]
  v_add_f32 v212, v212, v213
  v_mul_f32 v208, 0x3b000000, v208
  v_mul_f32 v212, 0x3b000000, v212
  v_fma_f32 v212, -v208, v208, v212
  v_max_f32 v212, 0, v212
  v_cvt_pk_bf16_f32 v168, v208, v212
  s_waitcnt lgkmcnt(4)
  v_mfma_f32_32x32x16_bf16 v[64:79], a[216:219], a[120:123], v[64:79]
  v_and_b32 v170, v10, v168
  v_add_f32 v170, 0x3727c5ac, v170
  v_cvt_pk_bf16_f32 v170, v170, v170
  v_and_b32 v170, v10, v170
  v_sqrt_f32 v170, v170
  s_waitcnt lgkmcnt(2)
  v_mfma_f32_32x32x16_bf16 v[64:79], a[220:223], a[124:127], v[64:79]
  v_xor_b32 v38, 0x80000000, v208
  v_cvt_pk_bf16_f32 v170, v170, v170
  v_and_b32 v170, v10, v170
  v_rcp_f32 v169, v170
  v_lshlrev_b32 v168, 16, v168
  v_mul_f32 v212, v212, v169
  v_mul_f32 v212, v212, v169
  v_cvt_pk_bf16_f32 v212, v212, v212
  v_and_b32 v212, v10, v212
  v_add_f32 v212, 0x3727c5ac, v212
  v_cvt_pk_bf16_f32 v212, v212, v212
  v_and_b32 v212, v10, v212
  v_sqrt_f32 v212, v212
  v_mul_f32 v171, 0xbdd2d3e8, v169
  v_cvt_pk_bf16_f32 v212, v212, v212
  v_and_b32 v212, v10, v212
  v_mul_f32 v39, v170, v212
  v_rcp_f32 v212, v212
  v_mul_f32 v171, v171, v169
  v_mul_f32 v208, v212, v169
  v_mul_f32 v171, v171, v212
  v_mul_f32 v36, 0xc0135761, v208
  v_mul_f32 v171, v171, v212
  v_mul_f32 v37, v171, v208
  s_waitcnt vmcnt(7)
  v_and_b32 v2, -16, v30
  v_cmp_ne_u32 vcc, s17, v2
  s_mov_b32 s13, 0
  s_nop 0
  s_cbranch_vccnz L_id_1
L_idd_2:
  s_or_b32 s7, s17, s19
  v_cmp_ne_u32 vcc, s7, v30
  s_nop 1
  s_cmp_lg_u64 vcc, 0
  s_cselect_b32 s18, 1, 0
  v_pk_fma_f32 v[64:65], v[80:81], v[38:39], v[64:65] op_sel_hi:[1,0,1]
  v_pk_fma_f32 v[66:67], v[82:83], v[38:39], v[66:67] op_sel_hi:[1,0,1]
  v_pk_fma_f32 v[68:69], v[84:85], v[38:39], v[68:69] op_sel_hi:[1,0,1]
  v_pk_fma_f32 v[70:71], v[86:87], v[38:39], v[70:71] op_sel_hi:[1,0,1]
  v_pk_fma_f32 v[72:73], v[88:89], v[38:39], v[72:73] op_sel_hi:[1,0,1]
  v_pk_fma_f32 v[74:75], v[90:91], v[38:39], v[74:75] op_sel_hi:[1,0,1]
  v_pk_fma_f32 v[76:77], v[92:93], v[38:39], v[76:77] op_sel_hi:[1,0,1]
  v_pk_fma_f32 v[78:79], v[94:95], v[38:39], v[78:79] op_sel_hi:[1,0,1]
  v_pk_mul_f32 v[128:129], v[64:65], v[64:65]
  v_pk_mul_f32 v[130:131], v[66:67], v[66:67]
  v_pk_mul_f32 v[132:133], v[68:69], v[68:69]
  v_pk_mul_f32 v[134:135], v[70:71], v[70:71]
  v_pk_mul_f32 v[136:137], v[72:73], v[72:73]
  v_pk_mul_f32 v[138:139], v[74:75], v[74:75]
  v_pk_mul_f32 v[140:141], v[76:77], v[76:77]
  v_pk_mul_f32 v[142:143], v[78:79], v[78:79]
  v_pk_fma_f32 v[128:129], v[128:129], v[36:37], v[36:37] op_sel:[0,1,0] op_sel_hi:[1,1,0]
  v_pk_fma_f32 v[130:131], v[130:131], v[36:37], v[36:37] op_sel:[0,1,0] op_sel_hi:[1,1,0]
  v_pk_fma_f32 v[132:133], v[132:133], v[36:37], v[36:37] op_sel:[0,1,0] op_sel_hi:[1,1,0]
  v_pk_fma_f32 v[134:135], v[134:135], v[36:37], v[36:37] op_sel:[0,1,0] op_sel_hi:[1,1,0]
  v_pk_fma_f32 v[136:137], v[136:137], v[36:37], v[36:37] op_sel:[0,1,0] op_sel_hi:[1,1,0]
  v_pk_fma_f32 v[138:139], v[138:139], v[36:37], v[36:37] op_sel:[0,1,0] op_sel_hi:[1,1,0]
  v_pk_fma_f32 v[140:141], v[140:141], v[36:37], v[36:37] op_sel:[0,1,0] op_sel_hi:[1,1,0]
  v_pk_fma_f32 v[142:143], v[142:143], v[36:37], v[36:37] op_sel:[0,1,0] op_sel_hi:[1,1,0]
  v_pk_mul_f32 v[128:129], v[128:129], v[64:65]
  v_pk_mul_f32 v[130:131], v[130:131], v[66:67]
  v_pk_mul_f32 v[132:133], v[132:133], v[68:69]
  v_pk_mul_f32 v[134:135], v[134:135], v[70:71]
  v_pk_mul_f32 v[136:137], v[136:137], v[72:73]
  v_pk_mul_f32 v[138:139], v[138:139], v[74:75]
  v_pk_mul_f32 v[140:141], v[140:141], v[76:77]
  v_pk_mul_f32 v[142:143], v[142:143], v[78:79]
  v_exp_f32 v128, v128
  v_exp_f32 v129, v129
  v_exp_f32 v130, v130
  v_exp_f32 v131, v131
  v_exp_f32 v132, v132
  v_exp_f32 v133, v133
  v_exp_f32 v134, v134
  v_exp_f32 v135, v135
  v_exp_f32 v136, v136
  v_exp_f32 v137, v137
  v_exp_f32 v138, v138
  v_exp_f32 v139, v139
  v_exp_f32 v140, v140
  v_exp_f32 v141, v141
  v_exp_f32 v142, v142
  v_exp_f32 v143, v143
  v_pk_fma_f32 v[128:129], v[128:129], v[38:39], v[38:39] op_sel:[0,1,1] op_sel_hi:[1,1,1]
  v_pk_fma_f32 v[130:131], v[130:131], v[38:39], v[38:39] op_sel:[0,1,1] op_sel_hi:[1,1,1]
  v_pk_fma_f32 v[132:133], v[132:133], v[38:39], v[38:39] op_sel:[0,1,1] op_sel_hi:[1,1,1]
  v_pk_fma_f32 v[134:135], v[134:135], v[38:39], v[38:39] op_sel:[0,1,1] op_sel_hi:[1,1,1]
  v_pk_fma_f32 v[136:137], v[136:137], v[38:39], v[38:39] op_sel:[0,1,1] op_sel_hi:[1,1,1]
  v_pk_fma_f32 v[138:139], v[138:139], v[38:39], v[38:39] op_sel:[0,1,1] op_sel_hi:[1,1,1]
  v_pk_fma_f32 v[140:141], v[140:141], v[38:39], v[38:39] op_sel:[0,1,1] op_sel_hi:[1,1,1]
  v_pk_fma_f32 v[142:143], v[142:143], v[38:39], v[38:39] op_sel:[0,1,1] op_sel_hi:[1,1,1]
  v_rcp_f32 v128, v128
  v_rcp_f32 v129, v129
  v_rcp_f32 v130, v130
  v_rcp_f32 v131, v131
  v_rcp_f32 v132, v132
  v_rcp_f32 v133, v133
  v_rcp_f32 v134, v134
  v_rcp_f32 v135, v135
  v_rcp_f32 v136, v136
  v_rcp_f32 v137, v137
  v_rcp_f32 v138, v138
  v_rcp_f32 v139, v139
  v_rcp_f32 v140, v140
  v_rcp_f32 v141, v141
  v_rcp_f32 v142, v142
  v_rcp_f32 v143, v143
  v_pk_mul_f32 v[128:129], v[128:129], v[64:65]
  v_pk_mul_f32 v[130:131], v[130:131], v[66:67]
  v_pk_mul_f32 v[132:133], v[132:133], v[68:69]
  v_pk_mul_f32 v[134:135], v[134:135], v[70:71]
  v_pk_mul_f32 v[136:137], v[136:137], v[72:73]
  v_pk_mul_f32 v[138:139], v[138:139], v[74:75]
  v_pk_mul_f32 v[140:141], v[140:141], v[76:77]
  v_pk_mul_f32 v[142:143], v[142:143], v[78:79]
  v_cvt_pk_bf16_f32 v104, v128, v129
  v_cvt_pk_bf16_f32 v105, v130, v131
  v_cvt_pk_bf16_f32 v106, v132, v133
  v_cvt_pk_bf16_f32 v107, v134, v135
  v_cvt_pk_bf16_f32 v108, v136, v137
  v_cvt_pk_bf16_f32 v109, v138, v139
  v_cvt_pk_bf16_f32 v110, v140, v141
  v_cvt_pk_bf16_f32 v111, v142, v143
  buffer_store_dwordx4 v[104:107], v222, s[88:91], s20 offen sc0 sc1
  buffer_store_dwordx4 v[108:111], v222, s[88:91], s20 offen offset:1024 sc0 sc1
  s_waitcnt lgkmcnt(0)
  buffer_store_dwordx4 v[96:99], v223, s[88:91], s20 offen sc0 sc1
  s_mov_b64 exec, 1
  s_cmp_lg_u32 s18, 0
  s_cbranch_scc1 L_slow_3
  buffer_store_dword v11, v12, s[88:91], s25 offen offset:256
L_sret_4:
  s_mov_b64 exec, -1
  s_lshl_b32 s6, s5, 8
  s_add_u32 s6, s6, 158720
  v_lshl_add_u32 v2, v9, 2, s6
  ds_write2_b32 v2, v168, v169 offset1:32
  s_sub_u32 s51, 0, s22
  s_not_b32 s50, s51
  s_add_u32 m0, s15, 0
  s_add_u32 s13, s27, 0
  buffer_load_dwordx4 v25, s[56:59], s13 offen offset:0 lds
  v_mul_u32_u24 v121, 1040, v6
  v_lshl_add_u32 v121, v7, 4, v121
  v_add_u32 v121, 65536, v121
  v_and_b32 v2, 7, v1
  v_bfe_u32 v3, v1, 3, 1
  v_lshl_add_u32 v2, v3, 5, v2
  s_lshl_b32 s6, s5, 3
  v_add_u32 v2, s6, v2
  v_lshlrev_b32 v199, 2, v2
  v_add_u32 v199, 163328, v199
  v_xor_b32 v2, 32, v2
  v_mul_u32_u24 v2, 1040, v2
  v_lshrrev_b32 v3, 4, v1
  v_lshl_add_u32 v198, v3, 4, v2
  v_add_u32 v198, 65536, v198
  s_add_u32 m0, s15, 16
  s_add_u32 s13, s27, 0
  buffer_load_dwordx4 v25, s[56:59], s13 offen offset:1024 lds
  v_bfe_u32 v232, v1, 1, 3
  v_xor_b32 v233, 4, v232
  v_sub_u32 v233, v233, v232
  v_mul_i32_i24 v239, 3584, v233
  v_mul_u32_u24 v232, 3584, v232
  v_and_b32 v233, 1, v1
  v_lshl_add_u32 v238, v233, 4, v232
  v_lshrrev_b32 v235, 4, v1
  v_mov_b32 v236, 28448
  s_mul_i32 s7, s4, 224
  v_add_u32 v238, s7, v238
  s_add_u32 m0, s15, 32
  s_add_u32 s13, s27, 0
  buffer_load_dwordx4 v25, s[56:59], s13 offen offset:2048 lds
  v_add_u32 v232, 0, v235
  v_mul_u32_u24 v233, 37, v232
  v_lshrrev_b32 v233, 8, v233
  v_add_u32 v234, v232, v233
  v_and_b32 v234, 1, v234
  v_lshl_add_u32 v232, v232, 5, v238
  v_mad_i32_i24 v232, v234, v239, v232
  v_mad_u32_u24 v176, v233, v236, v232
  v_add_u32 v232, 4, v235
  v_mul_u32_u24 v233, 37, v232
  s_add_u32 m0, s15, 48
  s_add_u32 s13, s27, 0
  buffer_load_dwordx4 v25, s[56:59], s13 offen offset:3072 lds
  v_lshrrev_b32 v233, 8, v233
  v_add_u32 v234, v232, v233
  v_and_b32 v234, 1, v234
  v_lshl_add_u32 v232, v232, 5, v238
  v_mad_i32_i24 v232, v234, v239, v232
  v_mad_u32_u24 v177, v233, v236, v232
  v_add_u32 v232, 8, v235
  v_mul_u32_u24 v233, 37, v232
  v_lshrrev_b32 v233, 8, v233
  v_add_u32 v234, v232, v233
  s_add_u32 m0, s15, 4160
  s_add_u32 s13, s27, 4096
  buffer_load_dwordx4 v25, s[56:59], s13 offen offset:0 lds
  v_and_b32 v234, 1, v234
  v_lshl_add_u32 v232, v232, 5, v238
  v_mad_i32_i24 v232, v234, v239, v232
  v_mad_u32_u24 v178, v233, v236, v232
  v_add_u32 v232, 12, v235
  v_mul_u32_u24 v233, 37, v232
  v_lshrrev_b32 v233, 8, v233
  v_add_u32 v234, v232, v233
  v_and_b32 v234, 1, v234
  v_lshl_add_u32 v232, v232, 5, v238
  s_add_u32 m0, s15, 4176
  s_add_u32 s13, s27, 4096
  buffer_load_dwordx4 v25, s[56:59], s13 offen offset:1024 lds
  v_mad_i32_i24 v232, v234, v239, v232
  v_mad_u32_u24 v179, v233, v236, v232
  v_add_u32 v232, 16, v235
  v_mul_u32_u24 v233, 37, v232
  v_lshrrev_b32 v233, 8, v233
  v_add_u32 v234, v232, v233
  v_and_b32 v234, 1, v234
  v_lshl_add_u32 v232, v232, 5, v238
L_stub1:
  s_cbranch_execz L_stub5
  v_mad_i32_i24 v232, v234, v239, v232
  v_mad_u32_u24 v252, v233, v236, v232
  s_add_u32 m0, s15, 4192
  s_add_u32 s13, s27, 4096
  buffer_load_dwordx4 v25, s[56:59], s13 offen offset:2048 lds
  v_add_u32 v232, 20, v235
  v_mul_u32_u24 v233, 37, v232
  v_lshrrev_b32 v233, 8, v233
  v_add_u32 v234, v232, v233
  v_and_b32 v234, 1, v234
  v_lshl_add_u32 v232, v232, 5, v238
  v_mad_i32_i24 v232, v234, v239, v232
  v_mad_u32_u24 v253, v233, v236, v232
  v_add_u32 v232, 24, v235
  v_mul_u32_u24 v233, 37, v232
  s_add_u32 m0, s15, 4208
  s_add_u32 s13, s27, 4096
  buffer_load_dwordx4 v25, s[56:59], s13 offen offset:3072 lds
  v_lshrrev_b32 v233, 8, v233
  v_add_u32 v234, v232, v233
  v_and_b32 v234, 1, v234
  v_lshl_add_u32 v232, v232, 5, v238
  v_mad_i32_i24 v232, v234, v239, v232
  v_mad_u32_u24 v254, v233, v236, v232
  s_xor_b32 s6, s22, 0
  s_lshl_b32 s6, s6, 10
  v_add_u32 v14, s6, v8
  s_xor_b32 s6, s22, 1
  s_lshl_b32 s6, s6, 10
  v_add_u32 v15, s6, v8
  buffer_load_dwordx4 v[200:203], v34, s[52:55], 0 offen
  s_lshl_b32 s6, s21, 2
  s_add_u32 s6, s6, s5
  s_lshl_b32 s7, s6, 10
  s_add_u32 s7, s7, 21757952
  s_mul_i32 s6, s6, 90112
  s_add_u32 s6, s6, 22020096
  v_and_b32 v20, 7, v1
  v_lshl_add_u32 v20, v20, 7, s7
  v_bfe_u32 v2, v1, 3, 2
  v_lshl_add_u32 v20, v2, 2, v20
  v_add_u32 v21, s6, v14
  v_add_u32 v22, s6, v15
  s_and_b32 s7, s3, 1
  s_lshl_b32 s7, s7, 1
  s_add_u32 s7, s7, s12
  s_lshl_b32 s7, s7, 13
  s_add_u32 s10, s6, s7
  s_add_u32 s6, s6, 65536
  v_add_u32 v9, s6, v8
  buffer_load_dwordx4 v[204:207], v34, s[52:55], 0 offen offset:32
  v_lshlrev_b32 v26, 16, v26
  v_lshlrev_b32 v27, 16, v27
  v_lshlrev_b32 v28, 16, v28
  v_mul_f32 v160, 0x3fb8aa3b, v28
  v_exp_f32 v160, v160
  s_nop 0
  v_cvt_pk_bf16_f32 v160, v160, v160
  v_lshlrev_b32 v160, 16, v160
  v_mul_f32 v161, v160, v26
  buffer_store_dwordx4 a[252:255], v8, s[88:91], s31 offen offset:0
  buffer_store_dwordx4 a[252:255], v8, s[88:91], s31 offen offset:1024
  v_mul_f32 v162, v160, v27
  v_mul_f32 v161, 0x3fb8aa3b, v161
  v_exp_f32 v161, v161
  v_mul_f32 v162, 0x3e22f983, v162
  v_rndne_f32 v163, v162
  v_sub_f32 v162, v162, v163
  v_cos_f32 v163, v162
  v_sin_f32 v164, v162
  s_and_b32 s13, s36, -16
  s_mov_b32 exec_hi, 0
  buffer_store_dwordx4 a[252:255], v8, s[88:91], s13 offen
  s_mov_b64 exec, -1
  v_mul_f32 v180, v161, v163
  v_mul_f32 v181, v161, v164
  v_add_f32 v160, -1.0, v180
  v_mul_f32 v161, v26, v26
  v_fmac_f32 v161, v27, v27
  v_rcp_f32 v161, v161
  s_nop 0
  v_add_f32 v161, v161, v161
  s_bitcmp1_b32 s29, 1
  s_cbranch_scc1 L_cim
  buffer_load_dwordx4 v[240:243], v192, s[64:67], 0 offen
  s_branch L_cdone
L_cim:
  buffer_load_dwordx4 v[240:243], v192, s[68:71], 0 offen
L_cdone:
  v_mul_f32 v162, v160, v26
  v_fmac_f32 v162, v181, v27
  v_mul_f32 v182, v162, v161
  v_mul_f32 v163, v181, v26
  v_fma_f32 v163, -v160, v27, v163
  v_mul_f32 v183, v163, v161
  v_mul_f32 v160, v181, v181
  v_mul_f32 v161, v180, v181
  v_fma_f32 v160, v180, v180, -v160
  v_add_f32 v161, v161, v161
  s_lshl_b32 s13, s5, 11
  s_add_u32 m0, s13, 148480
  s_nop 0
  buffer_load_dwordx4 v193, s[84:87], 0 offen lds
  v_mul_f32 v162, v161, v161
  v_mul_f32 v163, v160, v161
  v_fma_f32 v162, v160, v160, -v162
  v_add_f32 v163, v163, v163
  v_mul_f32 v160, v163, v163
  v_mul_f32 v161, v162, v163
  v_fma_f32 v160, v162, v162, -v160
  v_add_f32 v161, v161, v161
  v_mul_f32 v184, v161, v161
  v_mul_f32 v185, v160, v161
  s_lshl_b32 s13, s5, 11
  s_add_u32 m0, s13, 149504
  s_movk_i32 s13, 16384
  buffer_load_dwordx4 v193, s[84:87], s13 offen lds
  v_fma_f32 v184, v160, v160, -v184
  v_add_f32 v185, v185, v185
  v_mul_f32 v160, v185, v185
  s_waitcnt vmcnt(8)
  s_waitcnt lgkmcnt(0)
  s_barrier
  s_mul_i32 s11, s5, 7168
  s_and_b32 s20, s4, 3
  s_lshl_b32 s20, s20, 1
  s_add_u32 s20, s20, s5
  ds_read_b128 a[192:195], v121 offset:33280
  ds_read_b128 a[196:199], v121 offset:33312
  ds_read_b128 a[200:203], v121 offset:33344
  ds_read_b128 a[204:207], v121 offset:33376
  ds_read_b128 a[208:211], v121 offset:33408
  ds_read_b128 a[212:215], v121 offset:33440
  s_add_u32 m0, s92, 0
  s_mov_b32 s13, 0
  buffer_load_dwordx4 v197, s[76:79], s13 offen lds
  ds_read_b128 a[216:219], v121 offset:33472
  ds_read_b128 a[220:223], v121 offset:33504
  ds_read_b128 a[224:227], v121 offset:33536
  s_waitcnt lgkmcnt(8)
  v_mfma_f32_32x32x16_bf16 v[128:143], a[0:3], a[192:195], 0
  ds_read_b128 a[228:231], v121 offset:33568
  v_mul_f32 v161, v184, v185
  v_fma_f32 v160, v184, v184, -v160
  v_add_f32 v161, v161, v161
  v_mul_f32 v162, v161, v161
  v_mul_f32 v163, v160, v161
  s_waitcnt lgkmcnt(8)
  v_mfma_f32_32x32x16_bf16 v[128:143], a[4:7], a[196:199], v[128:143]
  ds_read_b128 a[232:235], v121 offset:33600
  s_add_u32 m0, s92, 1024
  s_mov_b32 s13, 8192
  buffer_load_dwordx4 v197, s[76:79], s13 offen lds
  v_fma_f32 v162, v160, v160, -v162
  v_add_f32 v163, v163, v163
  s_waitcnt lgkmcnt(8)
  v_mfma_f32_32x32x16_bf16 v[128:143], a[8:11], a[200:203], v[128:143]
  ds_read_b128 a[236:239], v121 offset:33632
  v_mul_f32 v186, v163, v163
  v_mul_f32 v187, v162, v163
  v_fma_f32 v186, v162, v162, -v186
  v_add_f32 v187, v187, v187
  v_mul_f32 v190, v187, v187
  s_waitcnt lgkmcnt(8)
  v_mfma_f32_32x32x16_bf16 v[128:143], a[12:15], a[204:207], v[128:143]
  ds_read_b128 a[192:195], v121 offset:33664
  v_mul_f32 v191, v186, v187
  s_add_u32 m0, s92, 2048
  s_mov_b32 s13, 16384
  buffer_load_dwordx4 v197, s[76:79], s13 offen lds
  v_fma_f32 v190, v186, v186, -v190
  s_waitcnt lgkmcnt(8)
  v_mfma_f32_32x32x16_bf16 v[128:143], a[16:19], a[208:211], v[128:143]
  ds_read_b128 a[196:199], v121 offset:33696
  v_add_f32 v191, v191, v191
  v_mov_b32 v166, 1.0
  v_mov_b32 v167, 0
  s_waitcnt lgkmcnt(8)
  v_mfma_f32_32x32x16_bf16 v[128:143], a[20:23], a[212:215], v[128:143]
  ds_read_b128 a[200:203], v121 offset:33728
  v_cmp_eq_u32 vcc, 1, v7
  s_nop 1
  v_cndmask_b32 v164, v166, v184, vcc
  v_cndmask_b32 v165, v167, v185, vcc
  s_add_u32 m0, s92, 3072
  s_mov_b32 s13, 24576
  buffer_load_dwordx4 v197, s[76:79], s13 offen lds
  s_waitcnt lgkmcnt(8)
  v_mfma_f32_32x32x16_bf16 v[128:143], a[24:27], a[216:219], v[128:143]
  ds_read_b128 a[204:207], v121 offset:33760
  s_bitcmp1_b32 s5, 0
  s_cselect_b64 vcc, -1, 0
  v_cndmask_b32 v160, v166, v160, vcc
  v_cndmask_b32 v161, v167, v161, vcc
  s_waitcnt lgkmcnt(8)
  v_mfma_f32_32x32x16_bf16 v[128:143], a[28:31], a[220:223], v[128:143]
  ds_read_b128 a[208:211], v121 offset:33792
  s_bitcmp1_b32 s5, 1
  s_cselect_b64 vcc, -1, 0
  v_cndmask_b32 v162, v166, v162, vcc
  v_cndmask_b32 v163, v167, v163, vcc
  s_add_u32 m0, s92, 4096
  s_mov_b32 s13, 32768
  buffer_load_dwordx4 v197, s[76:79], s13 offen lds
  s_waitcnt lgkmcnt(8)
  v_mfma_f32_32x32x16_bf16 v[128:143], a[32:35], a[224:227], v[128:143]
  ds_read_b128 a[212:215], v121 offset:33824
  v_mul_f32 v166, v165, v161
  v_mul_f32 v167, v164, v161
  v_fma_f32 v166, v164, v160, -v166
  v_fmac_f32 v167, v165, v160
  v_mul_f32 v188, v167, v163
  s_waitcnt lgkmcnt(8)
  v_mfma_f32_32x32x16_bf16 v[128:143], a[36:39], a[228:231], v[128:143]
  ds_read_b128 a[216:219], v121 offset:33856
  v_mul_f32 v189, v166, v163
  v_fma_f32 v188, v166, v162, -v188
  v_fmac_f32 v189, v167, v162
  s_add_u32 m0, s92, 5120
  s_mov_b32 s13, 40960
  buffer_load_dwordx4 v197, s[76:79], s13 offen lds
  s_waitcnt lgkmcnt(8)
  v_mfma_f32_32x32x16_bf16 v[128:143], a[40:43], a[232:235], v[128:143]
  ds_read_b128 a[220:223], v121 offset:33888
  ds_read2_b32 v[208:209], v196 offset1:32
  s_waitcnt vmcnt(13)
  v_lshlrev_b32 v64, 16, v200
  v_and_b32 v65, v10, v200
  v_lshlrev_b32 v66, 16, v201
  s_waitcnt lgkmcnt(9)
  v_mfma_f32_32x32x16_bf16 v[128:143], a[44:47], a[236:239], v[128:143]
  ds_read_b128 a[224:227], v121 offset:33920
  s_add_u32 m0, s92, 6144
  s_mov_b32 s13, 49152
  buffer_load_dwordx4 v197, s[76:79], s13 offen lds
  s_add_u32 m0, s92, 7168
  s_mov_b32 s13, 57344
  buffer_load_dwordx4 v197, s[76:79], s13 offen lds
  s_add_u32 m0, s92, 32768
  s_mov_b32 s13, 262144
  buffer_load_dwordx4 v197, s[76:79], s13 offen lds
  s_add_u32 m0, s92, 33792
  s_mov_b32 s13, 270336
  buffer_load_dwordx4 v197, s[76:79], s13 offen lds
  s_add_u32 m0, s92, 34816
  s_mov_b32 s13, 278528
  buffer_load_dwordx4 v197, s[76:79], s13 offen lds
  s_add_u32 m0, s92, 35840
  s_mov_b32 s13, 286720
  buffer_load_dwordx4 v197, s[76:79], s13 offen lds
  s_add_u32 m0, s92, 36864
  s_mov_b32 s13, 294912
  buffer_load_dwordx4 v197, s[76:79], s13 offen lds
  s_add_u32 m0, s92, 37888
  s_mov_b32 s13, 303104
  buffer_load_dwordx4 v197, s[76:79], s13 offen lds
  s_add_u32 m0, s92, 38912
  s_mov_b32 s13, 311296
  buffer_load_dwordx4 v197, s[76:79], s13 offen lds
  s_add_u32 m0, s92, 39936
  s_mov_b32 s13, 319488
  buffer_load_dwordx4 v197, s[76:79], s13 offen lds
  buffer_load_dword v23, v13, s[88:91], s24 offen offset:256 sc1
  s_waitcnt lgkmcnt(9)
  v_mfma_f32_32x32x16_bf16 v[128:143], a[48:51], a[192:195], v[128:143]
  ds_read_b128 a[228:231], v121 offset:33952
  v_and_b32 v67, v10, v201
  v_lshlrev_b32 v68, 16, v202
  v_and_b32 v69, v10, v202
  v_lshlrev_b32 v70, 16, v203
  v_and_b32 v71, v10, v203
  s_waitcnt lgkmcnt(9)
  v_mfma_f32_32x32x16_bf16 v[128:143], a[52:55], a[196:199], v[128:143]
  ds_read_b128 a[232:235], v121 offset:33984
  s_waitcnt vmcnt(23)
  v_lshlrev_b32 v72, 16, v204
  v_and_b32 v73, v10, v204
  v_lshlrev_b32 v74, 16, v205
  v_and_b32 v75, v10, v205
  s_waitcnt lgkmcnt(9)
  v_mfma_f32_32x32x16_bf16 v[128:143], a[56:59], a[200:203], v[128:143]
  ds_read_b128 a[236:239], v121 offset:34016
  v_lshlrev_b32 v76, 16, v206
  v_and_b32 v77, v10, v206
  v_lshlrev_b32 v78, 16, v207
  v_and_b32 v79, v10, v207
  s_waitcnt lgkmcnt(4)
  v_sub_f32 v64, v64, v208
  v_mfma_f32_32x32x16_bf16 v[128:143], a[60:63], a[204:207], v[128:143]
  ds_read_b128 a[192:195], v121 offset:34048
  v_sub_f32 v65, v65, v208
  v_sub_f32 v66, v66, v208
  v_sub_f32 v67, v67, v208
  v_sub_f32 v68, v68, v208
  v_sub_f32 v69, v69, v208
  v_mfma_f32_32x32x16_bf16 v[128:143], a[64:67], a[208:211], v[128:143]
  ds_read_b128 a[196:199], v121 offset:34080
  v_sub_f32 v70, v70, v208
  v_sub_f32 v71, v71, v208
  v_sub_f32 v72, v72, v208
  v_sub_f32 v73, v73, v208
  v_sub_f32 v74, v74, v208
  v_mfma_f32_32x32x16_bf16 v[128:143], a[68:71], a[212:215], v[128:143]
  ds_read_b128 a[200:203], v121 offset:34112
  v_sub_f32 v75, v75, v208
  v_sub_f32 v76, v76, v208
  v_sub_f32 v77, v77, v208
  v_sub_f32 v78, v78, v208
  v_sub_f32 v79, v79, v208
  v_mfma_f32_32x32x16_bf16 v[128:143], a[72:75], a[216:219], v[128:143]
  ds_read_b128 a[204:207], v121 offset:34144
  v_cvt_pk_bf16_f32 v36, v64, v65
  v_cvt_pk_bf16_f32 v37, v66, v67
  v_cvt_pk_bf16_f32 v38, v68, v69
  v_cvt_pk_bf16_f32 v39, v70, v71
  v_cvt_pk_bf16_f32 v40, v72, v73
  v_mfma_f32_32x32x16_bf16 v[128:143], a[76:79], a[220:223], v[128:143]
  ds_read_b128 a[208:211], v121 offset:34176
  v_cvt_pk_bf16_f32 v41, v74, v75
  v_cvt_pk_bf16_f32 v42, v76, v77
  v_cvt_pk_bf16_f32 v43, v78, v79
  v_lshlrev_b32 v64, 16, v36
  v_and_b32 v65, v10, v36
  s_waitcnt lgkmcnt(8)
  v_mfma_f32_32x32x16_bf16 v[128:143], a[80:83], a[224:227], v[128:143]
  ds_read_b128 a[212:215], v121 offset:34208
  v_lshlrev_b32 v66, 16, v37
  v_and_b32 v67, v10, v37
  v_lshlrev_b32 v68, 16, v38
  v_and_b32 v69, v10, v38
  v_lshlrev_b32 v70, 16, v39
  s_waitcnt lgkmcnt(8)
  v_mfma_f32_32x32x16_bf16 v[128:143], a[84:87], a[228:231], v[128:143]
  ds_read_b128 a[216:219], v121 offset:34240
  s_waitcnt vmcnt(0)
  v_cmp_ne_u32 vcc, v23, v11
  s_nop 1
  s_and_b64 vcc, vcc, s[50:51]
  s_cbranch_scc1 L_lz_5
L_lzr_6:
  buffer_load_dwordx4 a[128:131], v33, s[88:91], s28 offen offset:0 sc1
  s_waitcnt lgkmcnt(8)
  v_mfma_f32_32x32x16_bf16 v[128:143], a[88:91], a[232:235], v[128:143]
  ds_read_b128 a[220:223], v121 offset:34272
  v_and_b32 v71, v10, v39
  v_lshlrev_b32 v72, 16, v40
  v_and_b32 v73, v10, v40
  v_lshlrev_b32 v74, 16, v41
  buffer_load_dwordx4 a[132:135], v33, s[88:91], s28 offen offset:1024 sc1
  s_waitcnt lgkmcnt(8)
  v_mfma_f32_32x32x16_bf16 v[128:143], a[92:95], a[236:239], v[128:143]
  v_and_b32 v75, v10, v41
  v_lshlrev_b32 v76, 16, v42
  v_and_b32 v77, v10, v42
  v_lshlrev_b32 v78, 16, v43
  v_and_b32 v79, v10, v43
  buffer_load_dwordx4 a[136:139], v33, s[88:91], s28 offen offset:2048 sc1
  s_waitcnt lgkmcnt(7)
  v_mfma_f32_32x32x16_bf16 v[128:143], a[96:99], a[192:195], v[128:143]
  v_mul_f32 v64, v64, v209
  v_mul_f32 v65, v65, v209
  v_mul_f32 v66, v66, v209
  v_mul_f32 v67, v67, v209
  v_mul_f32 v68, v68, v209
  buffer_load_dwordx4 a[140:143], v33, s[88:91], s28 offen offset:3072 sc1
  s_waitcnt lgkmcnt(6)
  v_mfma_f32_32x32x16_bf16 v[128:143], a[100:103], a[196:199], v[128:143]
  v_mul_f32 v69, v69, v209
  v_mul_f32 v70, v70, v209
  v_mul_f32 v71, v71, v209
  v_mul_f32 v72, v72, v209
  v_mul_f32 v73, v73, v209
  s_add_u32 s28, s28, 4096
  s_and_b32 s28, s28, 16383
  buffer_load_dwordx4 a[144:147], v33, s[88:91], s28 offen offset:0 sc1
  s_waitcnt lgkmcnt(5)
  v_mfma_f32_32x32x16_bf16 v[128:143], a[104:107], a[200:203], v[128:143]
  v_mul_f32 v74, v74, v209
  v_mul_f32 v75, v75, v209
  v_mul_f32 v76, v76, v209
  v_mul_f32 v77, v77, v209
  v_mul_f32 v78, v78, v209
  buffer_load_dwordx4 a[148:151], v33, s[88:91], s28 offen offset:1024 sc1
  s_waitcnt lgkmcnt(4)
  v_mfma_f32_32x32x16_bf16 v[128:143], a[108:111], a[204:207], v[128:143]
  v_mul_f32 v79, v79, v209
  v_cvt_pk_bf16_f32 v36, v64, v65
  v_cvt_pk_bf16_f32 v37, v66, v67
  v_cvt_pk_bf16_f32 v38, v68, v69
  v_cvt_pk_bf16_f32 v39, v70, v71
  buffer_load_dwordx4 a[152:155], v33, s[88:91], s28 offen offset:2048 sc1
  s_waitcnt lgkmcnt(3)
  v_mfma_f32_32x32x16_bf16 v[128:143], a[112:115], a[208:211], v[128:143]
  v_cvt_pk_bf16_f32 v40, v72, v73
  v_cvt_pk_bf16_f32 v41, v74, v75
  v_cvt_pk_bf16_f32 v42, v76, v77
  v_cvt_pk_bf16_f32 v43, v78, v79
  v_lshlrev_b32 v64, 16, v36
  buffer_load_dwordx4 a[156:159], v33, s[88:91], s28 offen offset:3072 sc1
  s_waitcnt lgkmcnt(2)
  v_mfma_f32_32x32x16_bf16 v[128:143], a[116:119], a[212:215], v[128:143]
  v_and_b32 v65, v10, v36
  v_lshlrev_b32 v66, 16, v37
  v_and_b32 v67, v10, v37
  v_lshlrev_b32 v68, 16, v38
  v_and_b32 v69, v10, v38
  s_add_u32 s28, s28, 4096
  s_and_b32 s28, s28, 16383
  buffer_load_dwordx4 a[160:163], v33, s[88:91], s28 offen offset:0 sc1
  s_waitcnt lgkmcnt(1)
  v_mfma_f32_32x32x16_bf16 v[128:143], a[120:123], a[216:219], v[128:143]
  v_lshlrev_b32 v70, 16, v39
  v_and_b32 v71, v10, v39
  v_lshlrev_b32 v72, 16, v40
  v_and_b32 v73, v10, v40
  v_lshlrev_b32 v74, 16, v41
  buffer_load_dwordx4 a[164:167], v33, s[88:91], s28 offen offset:1024 sc1
  s_waitcnt lgkmcnt(0)
  v_mfma_f32_32x32x16_bf16 v[128:143], a[124:127], a[220:223], v[128:143]
  v_and_b32 v75, v10, v41
  v_lshlrev_b32 v76, 16, v42
  v_and_b32 v77, v10, v42
  v_lshlrev_b32 v78, 16, v43
  v_and_b32 v79, v10, v43
  buffer_load_dwordx4 a[168:171], v33, s[88:91], s28 offen offset:2048 sc1
  s_xor_b32 s6, s5, 1
  s_lshl_b32 s6, s6, 12
  s_add_u32 s6, s6, 132096
  v_add_u32 v3, s6, v8
  v_xor_b32 v4, 4096, v3
  s_barrier
  ds_read_b64_tr_b16 a[192:193], v119 offset:0
  buffer_load_dwordx4 a[172:175], v33, s[88:91], s28 offen offset:3072 sc1
  ds_read_b64_tr_b16 a[194:195], v119 offset:512
  ds_read_b64_tr_b16 a[196:197], v120 offset:0
  ds_read_b64_tr_b16 a[198:199], v120 offset:512
  ds_read_b64_tr_b16 a[200:201], v119 offset:2048
  ds_read_b64_tr_b16 a[202:203], v119 offset:2560
  ds_read_b64_tr_b16 a[204:205], v120 offset:2048
  ds_read_b64_tr_b16 a[206:207], v120 offset:2560
  ds_read_b64_tr_b16 a[208:209], v119 offset:4096
  s_add_u32 s28, s28, 4096
  s_and_b32 s28, s28, 16383
  buffer_load_dwordx4 a[176:179], v33, s[88:91], s28 offen offset:0 sc1
  ds_read_b64_tr_b16 a[210:211], v119 offset:4608
  ds_read_b64_tr_b16 a[212:213], v120 offset:4096
  ds_read_b64_tr_b16 a[214:215], v120 offset:4608
  s_waitcnt vmcnt(12)
  v_accvgpr_read_b32 v44, a128
  s_waitcnt vmcnt(11)
  v_accvgpr_read_b32 v45, a132
  v_cmp_u_f32 vcc, v44, v45
  s_cbranch_vccnz L_ck_7
L_ckr_8:
  buffer_load_dwordx4 a[180:183], v33, s[88:91], s28 offen offset:1024 sc1
  ds_read_b64_tr_b16 a[216:217], v119 offset:6144
  ds_read_b64_tr_b16 a[218:219], v119 offset:6656
  s_waitcnt lgkmcnt(12)
  v_mfma_f32_32x32x16_bf16 v[64:79], a[192:195], a[128:131], v[64:79]
  ds_read_b64_tr_b16 a[220:221], v120 offset:6144
  ds_read_b64_tr_b16 a[222:223], v120 offset:6656
  s_waitcnt vmcnt(11)
  v_accvgpr_read_b32 v44, a136
  buffer_load_dwordx4 a[184:187], v33, s[88:91], s28 offen offset:2048 sc1
  s_waitcnt lgkmcnt(12)
  v_mfma_f32_32x32x16_bf16 v[80:95], a[196:199], a[128:131], 0
  ds_read_b64_tr_b16 a[224:225], v119 offset:8192
  ds_read_b64_tr_b16 a[226:227], v119 offset:8704
  s_waitcnt vmcnt(11)
  v_accvgpr_read_b32 v45, a140
  s_waitcnt lgkmcnt(12)
  v_mfma_f32_32x32x16_bf16 v[64:79], a[200:203], a[132:135], v[64:79]
  ds_read_b64_tr_b16 a[228:229], v120 offset:8192
  buffer_load_dwordx4 a[188:191], v33, s[88:91], s28 offen offset:3072 sc1
  ds_read_b64_tr_b16 a[230:231], v120 offset:8704
  v_cmp_u_f32 vcc, v44, v45
  s_cbranch_vccnz L_ck_9
L_ckr_10:
  s_waitcnt lgkmcnt(12)
  v_mfma_f32_32x32x16_bf16 v[80:95], a[204:207], a[132:135], v[80:95]
  ds_read_b64_tr_b16 a[232:233], v119 offset:10240
  ds_read_b64_tr_b16 a[234:235], v119 offset:10752
  s_add_u32 m0, s15, 4294934016
  s_add_u32 s13, s27, 0
  buffer_load_dwordx4 v25, s[60:63], s13 offen offset:0 lds
  s_waitcnt lgkmcnt(12)
  v_mfma_f32_32x32x16_bf16 v[64:79], a[208:211], a[136:139], v[64:79]
  ds_read_b64_tr_b16 a[236:237], v120 offset:10240
  ds_read_b64_tr_b16 a[238:239], v120 offset:10752
  s_waitcnt vmcnt(12)
  v_accvgpr_read_b32 v44, a144
  s_waitcnt lgkmcnt(12)
  v_mfma_f32_32x32x16_bf16 v[80:95], a[212:215], a[136:139], v[80:95]
  ds_read_b64_tr_b16 a[192:193], v119 offset:12288
  s_add_u32 m0, s15, 4294934032
  s_add_u32 s13, s27, 0
  buffer_load_dwordx4 v25, s[60:63], s13 offen offset:1024 lds
  ds_read_b64_tr_b16 a[194:195], v119 offset:12800
  s_waitcnt vmcnt(12)
  v_accvgpr_read_b32 v45, a148
  s_waitcnt lgkmcnt(12)
  v_mfma_f32_32x32x16_bf16 v[64:79], a[216:219], a[140:143], v[64:79]
  ds_read_b64_tr_b16 a[196:197], v120 offset:12288
  ds_read_b64_tr_b16 a[198:199], v120 offset:12800
  s_add_u32 m0, s15, 4294934048
  s_add_u32 s13, s27, 0
  buffer_load_dwordx4 v25, s[60:63], s13 offen offset:2048 lds
  v_cmp_u_f32 vcc, v44, v45
  s_cbranch_vccnz L_ck_11
L_ckr_12:
  s_waitcnt lgkmcnt(12)
  v_mfma_f32_32x32x16_bf16 v[80:95], a[220:223], a[140:143], v[80:95]
  ds_read_b64_tr_b16 a[200:201], v119 offset:14336
  ds_read_b64_tr_b16 a[202:203], v119 offset:14848
  s_waitcnt lgkmcnt(12)
  v_mfma_f32_32x32x16_bf16 v[64:79], a[224:227], a[144:147], v[64:79]
  ds_read_b64_tr_b16 a[204:205], v120 offset:14336
  s_add_u32 m0, s15, 4294934064
  s_add_u32 s13, s27, 0
  buffer_load_dwordx4 v25, s[60:63], s13 offen offset:3072 lds
  ds_read_b64_tr_b16 a[206:207], v120 offset:14848
  s_waitcnt vmcnt(13)
  v_accvgpr_read_b32 v44, a152
  s_waitcnt lgkmcnt(12)
  v_mfma_f32_32x32x16_bf16 v[80:95], a[228:231], a[144:147], v[80:95]
  ds_read_b64_tr_b16 a[208:209], v119 offset:16384
  ds_read_b64_tr_b16 a[210:211], v119 offset:16896
  s_add_u32 m0, s15, 4294938176
  s_add_u32 s13, s27, 4096
  buffer_load_dwordx4 v25, s[60:63], s13 offen offset:0 lds
  s_waitcnt vmcnt(13)
  v_accvgpr_read_b32 v45, a156
  s_waitcnt lgkmcnt(12)
  v_mfma_f32_32x32x16_bf16 v[64:79], a[232:235], a[148:151], v[64:79]
  ds_read_b64_tr_b16 a[212:213], v120 offset:16384
  ds_read_b64_tr_b16 a[214:215], v120 offset:16896
  v_cmp_u_f32 vcc, v44, v45
  s_cbranch_vccnz L_ck_13
L_ckr_14:
  s_add_u32 m0, s15, 4294938192
  s_add_u32 s13, s27, 4096
  buffer_load_dwordx4 v25, s[60:63], s13 offen offset:1024 lds
  s_waitcnt lgkmcnt(12)
  v_mfma_f32_32x32x16_bf16 v[80:95], a[236:239], a[148:151], v[80:95]
  ds_read_b64_tr_b16 a[216:217], v119 offset:18432
  ds_read_b64_tr_b16 a[218:219], v119 offset:18944
  s_waitcnt lgkmcnt(12)
  v_mfma_f32_32x32x16_bf16 v[64:79], a[192:195], a[152:155], v[64:79]
  ds_read_b64_tr_b16 a[220:221], v120 offset:18432
  s_add_u32 m0, s15, 4294938208
  s_add_u32 s13, s27, 4096
  buffer_load_dwordx4 v25, s[60:63], s13 offen offset:2048 lds
  ds_read_b64_tr_b16 a[222:223], v120 offset:18944
  s_waitcnt vmcnt(14)
  v_accvgpr_read_b32 v44, a160
  s_waitcnt lgkmcnt(12)
  v_mfma_f32_32x32x16_bf16 v[80:95], a[196:199], a[152:155], v[80:95]
  ds_read_b64_tr_b16 a[224:225], v119 offset:20480
  ds_read_b64_tr_b16 a[226:227], v119 offset:20992
  s_add_u32 m0, s15, 4294938224
  s_add_u32 s13, s27, 4096
  buffer_load_dwordx4 v25, s[60:63], s13 offen offset:3072 lds
  s_waitcnt vmcnt(14)
  v_accvgpr_read_b32 v45, a164
  s_waitcnt lgkmcnt(12)
  v_mfma_f32_32x32x16_bf16 v[64:79], a[200:203], a[156:159], v[64:79]
  ds_read_b64_tr_b16 a[228:229], v120 offset:20480
  ds_read_b64_tr_b16 a[230:231], v120 offset:20992
  v_cmp_u_f32 vcc, v44, v45
  s_cbranch_vccnz L_ck_15
L_ckr_16:
  s_mul_i32 s13, s93, 7168
  s_mov_b32 m0, 156416
  s_mov_b32 exec_hi, 16777215
  buffer_load_dword v0, s[80:83], s13 offen offset:0 lds
  s_mov_b64 exec, -1
  s_waitcnt lgkmcnt(12)
  v_mfma_f32_32x32x16_bf16 v[80:95], a[204:207], a[156:159], v[80:95]
  ds_read_b64_tr_b16 a[232:233], v119 offset:22528
  ds_read_b64_tr_b16 a[234:235], v119 offset:23040
  s_waitcnt lgkmcnt(12)
  v_mfma_f32_32x32x16_bf16 v[64:79], a[208:211], a[160:163], v[64:79]
  ds_read_b64_tr_b16 a[236:237], v120 offset:22528
  ds_read_b64_tr_b16 a[238:239], v120 offset:23040
  s_waitcnt vmcnt(14)
  v_accvgpr_read_b32 v44, a168
  s_waitcnt lgkmcnt(12)
  v_mfma_f32_32x32x16_bf16 v[80:95], a[212:215], a[160:163], v[80:95]
  ds_read_b64_tr_b16 a[192:193], v119 offset:24576
  ds_read_b64_tr_b16 a[194:195], v119 offset:25088
  s_waitcnt vmcnt(13)
  v_accvgpr_read_b32 v45, a172
  s_waitcnt lgkmcnt(12)
  v_mfma_f32_32x32x16_bf16 v[64:79], a[216:219], a[164:167], v[64:79]
  ds_read_b64_tr_b16 a[196:197], v120 offset:24576
  ds_read_b64_tr_b16 a[198:199], v120 offset:25088
  v_cmp_u_f32 vcc, v44, v45
  s_cbranch_vccnz L_ck_17
L_ckr_18:
  s_waitcnt lgkmcnt(12)
  v_mfma_f32_32x32x16_bf16 v[80:95], a[220:223], a[164:167], v[80:95]
  ds_read_b64_tr_b16 a[200:201], v119 offset:26624
  ds_read_b64_tr_b16 a[202:203], v119 offset:27136
  s_waitcnt lgkmcnt(12)
  v_mfma_f32_32x32x16_bf16 v[64:79], a[224:227], a[168:171], v[64:79]
  ds_read_b64_tr_b16 a[204:205], v120 offset:26624
  ds_read_b64_tr_b16 a[206:207], v120 offset:27136
  s_waitcnt vmcnt(12)
  v_accvgpr_read_b32 v44, a176
  s_waitcnt lgkmcnt(12)
  v_mfma_f32_32x32x16_bf16 v[80:95], a[228:231], a[168:171], v[80:95]
  ds_read_b64_tr_b16 a[208:209], v119 offset:28672
  ds_read_b64_tr_b16 a[210:211], v119 offset:29184
  s_waitcnt vmcnt(11)
  v_accvgpr_read_b32 v45, a180
  s_waitcnt lgkmcnt(12)
  v_mfma_f32_32x32x16_bf16 v[64:79], a[232:235], a[172:175], v[64:79]
  ds_read_b64_tr_b16 a[212:213], v120 offset:28672
  ds_read_b64_tr_b16 a[214:215], v120 offset:29184
  v_cmp_u_f32 vcc, v44, v45
  s_cbranch_vccnz L_ck_19
L_ckr_20:
  s_waitcnt lgkmcnt(12)
  v_mfma_f32_32x32x16_bf16 v[80:95], a[236:239], a[172:175], v[80:95]
  ds_read_b64_tr_b16 a[216:217], v119 offset:30720
  ds_read_b64_tr_b16 a[218:219], v119 offset:31232
  s_waitcnt lgkmcnt(12)
  v_mfma_f32_32x32x16_bf16 v[64:79], a[192:195], a[176:179], v[64:79]
  ds_read_b64_tr_b16 a[220:221], v120 offset:30720
  ds_read_b64_tr_b16 a[222:223], v120 offset:31232
  s_waitcnt vmcnt(10)
  v_accvgpr_read_b32 v44, a184
  s_waitcnt lgkmcnt(12)
  v_mfma_f32_32x32x16_bf16 v[80:95], a[196:199], a[176:179], v[80:95]
  s_waitcnt vmcnt(9)
  v_accvgpr_read_b32 v45, a188
  s_waitcnt lgkmcnt(10)
  v_mfma_f32_32x32x16_bf16 v[64:79], a[200:203], a[180:183], v[64:79]
  v_cmp_u_f32 vcc, v44, v45
  s_cbranch_vccnz L_ck_21
L_ckr_22:
  s_waitcnt lgkmcnt(8)
  v_mfma_f32_32x32x16_bf16 v[80:95], a[204:207], a[180:183], v[80:95]
  s_waitcnt lgkmcnt(6)
  v_mfma_f32_32x32x16_bf16 v[64:79], a[208:211], a[184:187], v[64:79]
  s_waitcnt lgkmcnt(4)
  v_mfma_f32_32x32x16_bf16 v[80:95], a[212:215], a[184:187], v[80:95]
  s_waitcnt lgkmcnt(2)
  v_mfma_f32_32x32x16_bf16 v[64:79], a[216:219], a[188:191], v[64:79]
  s_waitcnt lgkmcnt(0)
  v_mfma_f32_32x32x16_bf16 v[80:95], a[220:223], a[188:191], v[80:95]
  s_nop 11
  ds_write_b128 v3, v[80:83] offset:0
  ds_write_b128 v3, v[84:87] offset:1024
  ds_write_b128 v3, v[88:91] offset:2048
  ds_write_b128 v3, v[92:95] offset:3072
  s_waitcnt lgkmcnt(0)
  s_barrier
  ds_read_b128 v[80:83], v4 offset:0
  ds_read_b128 v[84:87], v4 offset:1024
  ds_read_b128 v[88:91], v4 offset:2048
  ds_read_b128 v[92:95], v4 offset:3072
  s_waitcnt lgkmcnt(3)
  v_pk_add_f32 v[64:65], v[64:65], v[80:81]
  v_pk_add_f32 v[66:67], v[66:67], v[82:83]
  s_waitcnt lgkmcnt(2)
  v_pk_add_f32 v[68:69], v[68:69], v[84:85]
  v_pk_add_f32 v[70:71], v[70:71], v[86:87]
  s_waitcnt lgkmcnt(1)
  v_pk_add_f32 v[72:73], v[72:73], v[88:89]
  v_pk_add_f32 v[74:75], v[74:75], v[90:91]
  s_waitcnt lgkmcnt(0)
  v_pk_add_f32 v[76:77], v[76:77], v[92:93]
  v_pk_add_f32 v[78:79], v[78:79], v[94:95]
  v_cvt_pk_bf16_f32 v48, v64, v65
  v_cvt_pk_bf16_f32 v49, v66, v67
  v_cvt_pk_bf16_f32 v50, v68, v69
  v_cvt_pk_bf16_f32 v51, v70, v71
L_stub2:
  s_cbranch_execz L_stub6
  v_cvt_pk_bf16_f32 v52, v72, v73
  v_cvt_pk_bf16_f32 v53, v74, v75
  v_cvt_pk_bf16_f32 v54, v76, v77
  v_cvt_pk_bf16_f32 v55, v78, v79
  s_cmp_lg_u32 s18, 0
  s_cbranch_scc1 L_slow_23
  buffer_store_dwordx4 v[48:51], v8, s[88:91], s31 offen
  buffer_store_dwordx4 v[52:55], v8, s[88:91], s31 offen offset:1024
L_sret_24:
  v_dot2_f32_bf16 v80, v48, v18, 0
  v_dot2_f32_bf16 v81, v48, v48, 0
  v_dot2_f32_bf16 v82, v49, v18, 0
  v_dot2_f32_bf16 v83, v49, v49, 0
  v_dot2_f32_bf16 v80, v50, v18, v80
  v_dot2_f32_bf16 v81, v50, v50, v81
  v_dot2_f32_bf16 v82, v51, v18, v82
  v_dot2_f32_bf16 v83, v51, v51, v83
  v_dot2_f32_bf16 v80, v52, v18, v80
  v_dot2_f32_bf16 v81, v52, v52, v81
  v_dot2_f32_bf16 v82, v53, v18, v82
  v_dot2_f32_bf16 v83, v53, v53, v83
  v_dot2_f32_bf16 v80, v54, v18, v80
  v_dot2_f32_bf16 v81, v54, v54, v81
  v_dot2_f32_bf16 v82, v55, v18, v82
  v_dot2_f32_bf16 v83, v55, v55, v83
  s_nop 1
  v_add_f32 v80, v80, v82
  v_add_f32 v81, v81, v83
  v_mov_b32 v82, v80
  v_mov_b32 v83, v81
  s_nop 0
  v_permlane32_swap_b32 v80, v82
  v_permlane32_swap_b32 v81, v83
  v_add_f32 v80, v80, v82
  v_add_f32 v81, v81, v83
  s_mov_b32 exec_hi, 0
  s_cmp_lg_u32 s18, 0
  s_cbranch_scc1 L_slow_25
  buffer_store_dwordx2 v[80:81], v8, s[88:91], s36 offen
L_sret_26:
  s_mov_b64 exec, -1
  s_mov_b64 exec, 1
  s_cmp_lg_u32 s18, 0
  s_cbranch_scc1 L_slow_27
  buffer_store_dword v11, v12, s[88:91], s25 offen offset:512
L_sret_28:
  s_mov_b64 exec, -1
  v_mov_b32 v200, 0x3f803f80
  v_mov_b32 v201, 0x3f803f80
  v_mov_b32 v202, 0x3f803f80
  v_mov_b32 v203, 0x3f803f80
  s_waitcnt vmcnt(5)
  s_barrier
  ds_read_b128 a[192:195], v198 offset:0
  ds_read_b128 a[196:199], v198 offset:64
  ds_read_b128 a[200:203], v198 offset:128
  s_mul_i32 s13, s93, 7168
  s_add_u32 s13, s13, 917504
  s_mov_b32 m0, 156416
  s_mov_b32 exec_hi, 16777215
  buffer_load_dword v0, s[80:83], s13 offen offset:0 lds
  s_mov_b64 exec, -1
  ds_read_b128 a[204:207], v198 offset:192
  ds_read_b128 a[208:211], v198 offset:256
  ds_read_b128 a[212:215], v198 offset:320
  ds_read_b128 a[216:219], v198 offset:384
  ds_read_b128 a[220:223], v198 offset:448
  ds_read_b128 a[224:227], v198 offset:512
  s_waitcnt lgkmcnt(8)
  v_mfma_f32_16x16x32_bf16 v[204:207], v[200:203], a[192:195], 0
  ds_read_b128 a[228:231], v198 offset:576
  s_waitcnt lgkmcnt(8)
  v_mfma_f32_16x16x32_bf16 v[204:207], v[200:203], a[196:199], v[204:207]
  ds_read_b128 a[232:235], v198 offset:640
  s_lshl_b32 s6, s5, 11
  s_add_u32 s6, s6, 148480
  v_add_u32 v5, s6, v16
  v_bfe_u32 v244, v1, 2, 2
  v_lshl_add_u32 v5, v244, 6, v5
  v_mul_u32_u24 v244, 448, v7
  v_sub_u32 v5, v5, v244
  ds_read_b64_tr_b16 v[244:245], v5 offset:0
  ds_read_b64_tr_b16 v[246:247], v5 offset:512
  ds_read_b64_tr_b16 v[248:249], v5 offset:1024
  ds_read_b64_tr_b16 v[250:251], v5 offset:1536
  buffer_store_dwordx4 v[240:243], v194, s[88:91], 0 offen sc0 sc1
  s_waitcnt lgkmcnt(12)
  v_mfma_f32_16x16x32_bf16 v[204:207], v[200:203], a[200:203], v[204:207]
  ds_read_b128 a[236:239], v198 offset:704
  s_waitcnt lgkmcnt(12)
  v_mfma_f32_16x16x32_bf16 v[204:207], v[200:203], a[204:207], v[204:207]
  ds_read_b128 a[192:195], v198 offset:768
  s_waitcnt lgkmcnt(12)
  v_mfma_f32_16x16x32_bf16 v[204:207], v[200:203], a[208:211], v[204:207]
  ds_read_b128 a[196:199], v198 offset:832
  s_waitcnt lgkmcnt(5)
  buffer_store_dwordx4 v[244:247], v195, s[88:91], 0 offen sc0 sc1
  v_mfma_f32_16x16x32_bf16 v[204:207], v[200:203], a[212:215], v[204:207]
  ds_read_b128 a[200:203], v198 offset:896
  v_mfma_f32_16x16x32_bf16 v[204:207], v[200:203], a[216:219], v[204:207]
  ds_read_b128 a[204:207], v198 offset:960
  v_mfma_f32_16x16x32_bf16 v[204:207], v[200:203], a[220:223], v[204:207]
  ds_read_b128 a[208:211], v121 offset:0
  s_cmp_eq_u32 s5, 3
  s_cselect_b32 s13, 0x80000000, 0
  s_waitcnt lgkmcnt(6)
  buffer_store_dwordx4 v[248:251], v195, s[88:91], s13 offen offset:2048 sc0 sc1
  v_mfma_f32_16x16x32_bf16 v[204:207], v[200:203], a[224:227], v[204:207]
  ds_read_b128 a[212:215], v121 offset:32
  v_mfma_f32_16x16x32_bf16 v[204:207], v[200:203], a[228:231], v[204:207]
  ds_read_b128 a[216:219], v121 offset:64
  v_mfma_f32_16x16x32_bf16 v[204:207], v[200:203], a[232:235], v[204:207]
  ds_read_b128 a[220:223], v121 offset:96
  s_waitcnt lgkmcnt(8)
  v_mfma_f32_16x16x32_bf16 v[204:207], v[200:203], a[236:239], v[204:207]
  ds_read_b128 a[224:227], v121 offset:128
  s_waitcnt lgkmcnt(8)
  v_mfma_f32_16x16x32_bf16 v[204:207], v[200:203], a[192:195], v[204:207]
  ds_read_b128 a[228:231], v121 offset:160
  s_waitcnt lgkmcnt(8)
  v_mfma_f32_16x16x32_bf16 v[204:207], v[200:203], a[196:199], v[204:207]
  ds_read_b128 a[232:235], v121 offset:192
  s_waitcnt lgkmcnt(8)
  v_mfma_f32_16x16x32_bf16 v[204:207], v[200:203], a[200:203], v[204:207]
  ds_read_b128 a[236:239], v121 offset:224
  s_waitcnt lgkmcnt(8)
  v_mfma_f32_16x16x32_bf16 v[204:207], v[200:203], a[204:207], v[204:207]
  ds_read_b128 a[192:195], v121 offset:256
  s_waitcnt lgkmcnt(8)
  v_mfma_f32_32x32x16_bf16 v[144:159], a[0:3], a[208:211], 0
  ds_read_b128 a[196:199], v121 offset:288
  s_mov_b32 s7, s21
  s_and_b32 s15, s7, 3
  s_lshl_b32 s15, s15, 12
  s_mov_b32 s27, s15
  s_lshl_b32 s14, s15, 1
  s_mul_i32 s6, s7, 11
  s_lshr_b32 s6, s6, 5
  s_mul_i32 s6, s6, 3
  s_sub_u32 s6, s7, s6
  s_mul_i32 s31, s6, 8192
  s_mul_i32 s38, s6, 4096
  s_waitcnt lgkmcnt(8)
  v_mfma_f32_32x32x16_bf16 v[144:159], a[4:7], a[212:215], v[144:159]
  ds_read_b128 a[200:203], v121 offset:320
  v_bfe_u32 v3, v1, 4, 1
  v_lshlrev_b32 v4, 2, v3
  v_bfe_u32 v2, v1, 2, 2
  v_add_u32 v2, v2, v4
  v_lshlrev_b32 v2, 5, v2
  v_lshl_add_u32 v2, v3, 8, v2
  v_and_b32 v3, 1, v1
  v_lshl_add_u32 v2, v3, 4, v2
  v_bfe_u32 v3, v1, 1, 1
  v_lshl_add_u32 v2, v3, 3, v2
  v_mul_u32_u24 v3, 1792, v7
  v_add_u32 v28, v2, v3
  v_xor_b32 v29, 128, v28
  s_waitcnt lgkmcnt(8)
  v_mfma_f32_32x32x16_bf16 v[144:159], a[8:11], a[216:219], v[144:159]
  ds_read_b128 a[204:207], v121 offset:352
  ds_write_b32 v199, v204
  v_add_u32 v30, 69632, v28
  v_add_u32 v31, 69632, v29
  s_waitcnt lgkmcnt(9)
  v_mfma_f32_32x32x16_bf16 v[144:159], a[12:15], a[220:223], v[144:159]
  ds_read_b128 a[208:211], v121 offset:384
  s_lshl_b32 s7, s22, 1
  s_lshl_b32 s6, 0x33333333, s7
  s_bitcmp1_b32 s5, 1
  s_cselect_b32 s50, 0, s6
  s_cselect_b32 s51, s6, 0
  s_waitcnt lgkmcnt(9)
  v_mfma_f32_32x32x16_bf16 v[144:159], a[16:19], a[224:227], v[144:159]
  ds_read_b128 a[212:215], v121 offset:416
  s_lshl_b32 s6, s5, 15
  s_add_u32 s6, s6, s16
  s_add_u32 s6, s6, 262144
  v_add_u32 v33, s6, v8
  s_and_b32 s28, s4, 3
  s_lshl_b32 s28, s28, 12
  s_waitcnt lgkmcnt(9)
  v_mfma_f32_32x32x16_bf16 v[144:159], a[20:23], a[228:231], v[144:159]
  ds_read_b128 a[216:219], v121 offset:448
  s_lshl_b32 s37, s5, 12
  s_add_u32 s37, s37, s16
  s_add_u32 s37, s37, 1118208
  s_waitcnt lgkmcnt(9)
  v_mfma_f32_32x32x16_bf16 v[144:159], a[24:27], a[232:235], v[144:159]
  ds_read_b128 a[220:223], v121 offset:480
  s_lshl_b32 s7, s12, 1
  s_lshl_b32 s6, 0x3333, s7
  s_lshl_b32 s8, s5, 4
  s_mov_b32 s40, s6
  s_mov_b32 s41, 0
  s_lshl_b64 s[40:41], s[40:41], s8
  s_waitcnt lgkmcnt(9)
  v_mfma_f32_32x32x16_bf16 v[144:159], a[28:31], a[236:239], v[144:159]
  ds_read_b128 a[224:227], v121 offset:512
  s_waitcnt lgkmcnt(5)
  s_barrier
  v_lshlrev_b32 v2, 2, v6
  v_add_u32 v2, 163328, v2
  ds_read2_b32 v[56:57], v2 offset1:32
  v_mfma_f32_32x32x16_bf16 v[144:159], a[32:35], a[192:195], v[144:159]
  ds_read_b128 a[228:231], v121 offset:544
  s_xor_b32 s6, s23, 0
  s_lshl_b32 s7, s12, 1
  s_add_u32 s6, s6, s7
  s_mul_i32 s6, s6, 64
  s_mul_i32 s7, s5, 16
  s_add_u32 s6, s6, s7
  s_lshl_b32 s6, s6, 10
  s_add_u32 s6, s6, s16
  s_add_u32 s6, s6, 393216
  v_add_u32 v24, s6, v8
  v_mfma_f32_32x32x16_bf16 v[144:159], a[36:39], a[196:199], v[144:159]
  ds_read_b128 a[232:235], v121 offset:576
  s_xor_b32 s6, s23, 1
  s_lshl_b32 s7, s12, 1
  s_add_u32 s6, s6, s7
  s_mul_i32 s6, s6, 64
  s_mul_i32 s7, s5, 16
  s_add_u32 s6, s6, s7
  s_lshl_b32 s6, s6, 10
  s_add_u32 s6, s6, s16
  s_add_u32 s6, s6, 393216
  v_add_u32 v25, s6, v8
  v_mfma_f32_32x32x16_bf16 v[144:159], a[40:43], a[200:203], v[144:159]
  ds_read_b128 a[236:239], v121 offset:608
  s_xor_b32 s6, s23, 0
  s_lshl_b32 s7, s12, 1
  s_add_u32 s6, s6, s7
  s_mul_i32 s6, s6, 112
  s_mul_i32 s7, s5, 28
  s_add_u32 s6, s6, s7
  s_lshl_b32 s6, s6, 10
  s_add_u32 s6, s6, s16
  s_add_u32 s6, s6, 655360
  v_add_u32 v26, s6, v8
  v_mfma_f32_32x32x16_bf16 v[144:159], a[44:47], a[204:207], v[144:159]
  ds_read_b128 a[192:195], v121 offset:640
  s_xor_b32 s6, s23, 1
  s_lshl_b32 s7, s12, 1
  s_add_u32 s6, s6, s7
  s_mul_i32 s6, s6, 112
  s_mul_i32 s7, s5, 28
  s_add_u32 s6, s6, s7
  s_lshl_b32 s6, s6, 10
  s_add_u32 s6, s6, s16
  s_add_u32 s6, s6, 655360
  v_add_u32 v27, s6, v8
  s_waitcnt lgkmcnt(9)
  v_mfma_f32_32x32x16_bf16 v[144:159], a[48:51], a[208:211], v[144:159]
  ds_read_b128 a[196:199], v121 offset:672
  s_lshl_b32 s6, s5, 6
  s_lshl_b32 s7, s4, 2
  s_add_u32 s6, s6, s7
  s_lshl_b32 s6, s6, 10
  s_add_u32 s6, s6, s16
  s_add_u32 s39, s6, 393216
  s_waitcnt lgkmcnt(9)
  v_mfma_f32_32x32x16_bf16 v[144:159], a[52:55], a[212:215], v[144:159]
  ds_read_b128 a[200:203], v121 offset:704
  s_mul_i32 s6, s5, 112
  s_lshr_b32 s7, s4, 2
  s_mul_i32 s7, s7, 28
  s_add_u32 s6, s6, s7
  s_lshl_b32 s6, s6, 10
  s_add_u32 s6, s6, s16
  s_add_u32 s6, s6, 655360
  s_and_b32 s7, s4, 3
  s_lshl_b32 s8, s7, 12
  s_add_u32 s42, s6, s8
  s_mul_i32 s8, s7, 3072
  s_add_u32 s43, s6, s8
  s_add_u32 s43, s43, 16384
  s_lshl_b32 s36, s5, 11
  s_waitcnt lgkmcnt(9)
  v_mfma_f32_32x32x16_bf16 v[144:159], a[56:59], a[216:219], v[144:159]
  ds_read_b128 a[204:207], v121 offset:736
  s_lshl_b32 s48, s4, 9
  s_add_u32 s48, s48, 20971520
  s_mul_i32 s49, s5, 5120
  s_add_u32 s49, s49, 124928
  s_waitcnt lgkmcnt(9)
  v_mfma_f32_32x32x16_bf16 v[144:159], a[60:63], a[220:223], v[144:159]
  ds_read_b128 a[208:211], v121 offset:768
  v_bfe_u32 v2, v1, 2, 2
  v_lshlrev_b32 v2, 5, v2
  v_and_b32 v3, 3, v1
  v_lshl_add_u32 v2, v3, 3, v2
  v_lshrrev_b32 v3, 4, v1
  v_mul_u32_u24 v3, 1792, v3
  v_add_u32 v2, v2, v3
  v_add_u32 v32, s11, v2
  v_add_u32 v35, 69632, v32
  s_waitcnt lgkmcnt(9)
  v_mfma_f32_32x32x16_bf16 v[144:159], a[64:67], a[224:227], v[144:159]
  ds_read_b128 a[212:215], v121 offset:800
  s_lshl_b32 s6, s5, 9
  s_add_u32 s6, s6, 156672
  v_lshrrev_b32 v2, 4, v1
  v_lshl_add_u32 v46, v2, 4, s6
  s_waitcnt lgkmcnt(8)
  v_mfma_f32_32x32x16_bf16 v[144:159], a[68:71], a[228:231], v[144:159]
  ds_read_b128 a[216:219], v121 offset:832
  s_add_u32 m0, s11, 0
  s_add_u32 s26, s20, 0
  s_and_b32 s26, s26, 7
  s_mul_i32 s26, s26, 114688
  buffer_load_dwordx4 v176, s[80:83], s26 offen lds
  s_waitcnt lgkmcnt(8)
  v_mfma_f32_32x32x16_bf16 v[144:159], a[72:75], a[232:235], v[144:159]
  ds_read_b128 a[220:223], v121 offset:864
  s_sub_u32 s6, s3, 1
  v_sub_u32 v2, s6, v7
  v_lshlrev_b32 v2, 13, v2
  v_lshl_add_u32 v18, v6, 4, v2
  s_waitcnt lgkmcnt(8)
  v_mfma_f32_32x32x16_bf16 v[144:159], a[76:79], a[236:239], v[144:159]
  ds_read_b128 a[224:227], v121 offset:896
  s_add_u32 m0, s11, 1024
  s_nop 0
  buffer_load_dwordx4 v177, s[80:83], s26 offen lds
  s_waitcnt lgkmcnt(8)
  v_mfma_f32_32x32x16_bf16 v[144:159], a[80:83], a[192:195], v[144:159]
  ds_read_b128 a[228:231], v121 offset:928
  s_lshl_b32 s6, s5, 8
  s_add_u32 s6, s6, 158720
  v_lshl_add_u32 v2, v7, 6, s6
  ds_read_b128 v[208:211], v2 offset:0
  ds_read_b128 v[212:215], v2 offset:16
  ds_read_b128 v[216:219], v2 offset:32
  ds_read_b128 v[220:223], v2 offset:48
  ds_read_b128 v[224:227], v2 offset:128
  ds_read_b128 v[228:231], v2 offset:144
  ds_read_b128 v[232:235], v2 offset:160
  ds_read_b128 v[236:239], v2 offset:176
  s_add_u32 m0, s11, 2048
  s_nop 0
  buffer_load_dwordx4 v178, s[80:83], s26 offen lds
  v_mfma_f32_32x32x16_bf16 v[144:159], a[84:87], a[196:199], v[144:159]
  ds_read_b128 a[232:235], v121 offset:960
  v_mfma_f32_32x32x16_bf16 v[144:159], a[88:91], a[200:203], v[144:159]
  ds_read_b128 a[236:239], v121 offset:992
  s_add_u32 m0, s11, 3072
  s_nop 0
  buffer_load_dwordx4 v179, s[80:83], s26 offen lds
  v_mfma_f32_32x32x16_bf16 v[144:159], a[92:95], a[204:207], v[144:159]
  buffer_load_dword v23, v13, s[88:91], s24 offen offset:512 sc1
  s_waitcnt lgkmcnt(15)
  v_mfma_f32_32x32x16_bf16 v[144:159], a[96:99], a[208:211], v[144:159]
  s_waitcnt lgkmcnt(14)
  v_mfma_f32_32x32x16_bf16 v[144:159], a[100:103], a[212:215], v[144:159]
  s_add_u32 m0, s11, 4096
  s_nop 0
  buffer_load_dwordx4 v252, s[80:83], s26 offen lds
  s_waitcnt lgkmcnt(13)
  v_mfma_f32_32x32x16_bf16 v[144:159], a[104:107], a[216:219], v[144:159]
  s_waitcnt lgkmcnt(12)
  v_mfma_f32_32x32x16_bf16 v[144:159], a[108:111], a[220:223], v[144:159]
  s_add_u32 m0, s11, 5120
  s_nop 0
  buffer_load_dwordx4 v253, s[80:83], s26 offen lds
  s_waitcnt lgkmcnt(11)
  v_mfma_f32_32x32x16_bf16 v[144:159], a[112:115], a[224:227], v[144:159]
  s_waitcnt lgkmcnt(10)
  v_mfma_f32_32x32x16_bf16 v[144:159], a[116:119], a[228:231], v[144:159]
  s_add_u32 m0, s11, 6144
  s_nop 0
  buffer_load_dwordx4 v254, s[80:83], s26 offen lds
  s_waitcnt lgkmcnt(1)
  v_mfma_f32_32x32x16_bf16 v[144:159], a[120:123], a[232:235], v[144:159]
  s_waitcnt lgkmcnt(0)
  v_mfma_f32_32x32x16_bf16 v[144:159], a[124:127], a[236:239], v[144:159]
  s_waitcnt vmcnt(8)
  s_mov_b64 exec, 1
  buffer_store_dword v11, v12, s[88:91], s30 offen sc0 sc1
  s_mov_b64 exec, -1
  v_pk_fma_f32 v[128:129], v[208:209], v[56:57], v[128:129] op_sel_hi:[1,0,1] neg_lo:[1,0,0] neg_hi:[1,0,0]
  s_nop 6
  v_pk_fma_f32 v[144:145], v[208:209], v[56:57], v[144:145] op_sel:[0,1,0] op_sel_hi:[1,1,1] neg_lo:[1,0,0] neg_hi:[1,0,0]
  s_add_u32 m0, s11, 28672
  s_add_u32 s26, s20, 4
  s_and_b32 s26, s26, 7
  s_mul_i32 s26, s26, 114688
  buffer_load_dwordx4 v176, s[80:83], s26 offen lds
  v_pk_fma_f32 v[130:131], v[210:211], v[56:57], v[130:131] op_sel_hi:[1,0,1] neg_lo:[1,0,0] neg_hi:[1,0,0]
  v_pk_fma_f32 v[146:147], v[210:211], v[56:57], v[146:147] op_sel:[0,1,0] op_sel_hi:[1,1,1] neg_lo:[1,0,0] neg_hi:[1,0,0]
  v_pk_fma_f32 v[132:133], v[212:213], v[56:57], v[132:133] op_sel_hi:[1,0,1] neg_lo:[1,0,0] neg_hi:[1,0,0]
  v_pk_fma_f32 v[148:149], v[212:213], v[56:57], v[148:149] op_sel:[0,1,0] op_sel_hi:[1,1,1] neg_lo:[1,0,0] neg_hi:[1,0,0]
  v_pk_fma_f32 v[134:135], v[214:215], v[56:57], v[134:135] op_sel_hi:[1,0,1] neg_lo:[1,0,0] neg_hi:[1,0,0]
  v_pk_fma_f32 v[150:151], v[214:215], v[56:57], v[150:151] op_sel:[0,1,0] op_sel_hi:[1,1,1] neg_lo:[1,0,0] neg_hi:[1,0,0]
  v_pk_fma_f32 v[136:137], v[216:217], v[56:57], v[136:137] op_sel_hi:[1,0,1] neg_lo:[1,0,0] neg_hi:[1,0,0]
  v_pk_fma_f32 v[152:153], v[216:217], v[56:57], v[152:153] op_sel:[0,1,0] op_sel_hi:[1,1,1] neg_lo:[1,0,0] neg_hi:[1,0,0]
  v_pk_fma_f32 v[138:139], v[218:219], v[56:57], v[138:139] op_sel_hi:[1,0,1] neg_lo:[1,0,0] neg_hi:[1,0,0]
  v_pk_fma_f32 v[154:155], v[218:219], v[56:57], v[154:155] op_sel:[0,1,0] op_sel_hi:[1,1,1] neg_lo:[1,0,0] neg_hi:[1,0,0]
  s_add_u32 m0, s11, 29696
  s_nop 0
  buffer_load_dwordx4 v177, s[80:83], s26 offen lds
  v_pk_fma_f32 v[140:141], v[220:221], v[56:57], v[140:141] op_sel_hi:[1,0,1] neg_lo:[1,0,0] neg_hi:[1,0,0]
  v_pk_fma_f32 v[156:157], v[220:221], v[56:57], v[156:157] op_sel:[0,1,0] op_sel_hi:[1,1,1] neg_lo:[1,0,0] neg_hi:[1,0,0]
  v_pk_fma_f32 v[142:143], v[222:223], v[56:57], v[142:143] op_sel_hi:[1,0,1] neg_lo:[1,0,0] neg_hi:[1,0,0]
  v_pk_fma_f32 v[158:159], v[222:223], v[56:57], v[158:159] op_sel:[0,1,0] op_sel_hi:[1,1,1] neg_lo:[1,0,0] neg_hi:[1,0,0]
  v_pk_mul_f32 v[128:129], v[224:225], v[128:129]
  v_pk_mul_f32 v[144:145], v[224:225], v[144:145]
  v_pk_mul_f32 v[130:131], v[226:227], v[130:131]
  v_pk_mul_f32 v[146:147], v[226:227], v[146:147]
  v_pk_mul_f32 v[132:133], v[228:229], v[132:133]
  v_pk_mul_f32 v[148:149], v[228:229], v[148:149]
  s_add_u32 m0, s11, 30720
  s_nop 0
  buffer_load_dwordx4 v178, s[80:83], s26 offen lds
  v_pk_mul_f32 v[134:135], v[230:231], v[134:135]
  v_pk_mul_f32 v[150:151], v[230:231], v[150:151]
  v_pk_mul_f32 v[136:137], v[232:233], v[136:137]
  v_pk_mul_f32 v[152:153], v[232:233], v[152:153]
  v_pk_mul_f32 v[138:139], v[234:235], v[138:139]
  v_pk_mul_f32 v[154:155], v[234:235], v[154:155]
  v_pk_mul_f32 v[140:141], v[236:237], v[140:141]
  v_pk_mul_f32 v[156:157], v[236:237], v[156:157]
  v_pk_mul_f32 v[142:143], v[238:239], v[142:143]
  v_pk_mul_f32 v[158:159], v[238:239], v[158:159]
  s_add_u32 m0, s11, 31744
  s_nop 0
  buffer_load_dwordx4 v179, s[80:83], s26 offen lds
  v_pk_mul_f32 v[208:209], v[144:145], v[182:183] op_sel:[0,1] op_sel_hi:[1,1]
  v_pk_mul_f32 v[144:145], v[144:145], v[182:183] op_sel_hi:[1,0]
  v_pk_mul_f32 v[210:211], v[146:147], v[182:183] op_sel:[0,1] op_sel_hi:[1,1]
  v_pk_mul_f32 v[146:147], v[146:147], v[182:183] op_sel_hi:[1,0]
  v_pk_mul_f32 v[212:213], v[148:149], v[182:183] op_sel:[0,1] op_sel_hi:[1,1]
  v_pk_mul_f32 v[148:149], v[148:149], v[182:183] op_sel_hi:[1,0]
  v_pk_mul_f32 v[214:215], v[150:151], v[182:183] op_sel:[0,1] op_sel_hi:[1,1]
  v_pk_mul_f32 v[150:151], v[150:151], v[182:183] op_sel_hi:[1,0]
  v_pk_mul_f32 v[216:217], v[152:153], v[182:183] op_sel:[0,1] op_sel_hi:[1,1]
  v_pk_mul_f32 v[152:153], v[152:153], v[182:183] op_sel_hi:[1,0]
  s_add_u32 m0, s11, 32768
  s_nop 0
  buffer_load_dwordx4 v252, s[80:83], s26 offen lds
  v_pk_mul_f32 v[218:219], v[154:155], v[182:183] op_sel:[0,1] op_sel_hi:[1,1]
  v_pk_mul_f32 v[154:155], v[154:155], v[182:183] op_sel_hi:[1,0]
  v_pk_mul_f32 v[220:221], v[156:157], v[182:183] op_sel:[0,1] op_sel_hi:[1,1]
  v_pk_mul_f32 v[156:157], v[156:157], v[182:183] op_sel_hi:[1,0]
  v_pk_mul_f32 v[222:223], v[158:159], v[182:183] op_sel:[0,1] op_sel_hi:[1,1]
  v_pk_mul_f32 v[158:159], v[158:159], v[182:183] op_sel_hi:[1,0]
  v_pk_fma_f32 v[144:145], v[128:129], v[182:183], v[144:145] op_sel:[0,1,0] op_sel_hi:[1,1,1]
  v_pk_fma_f32 v[128:129], v[128:129], v[182:183], v[208:209] op_sel_hi:[1,0,1] neg_lo:[0,0,1] neg_hi:[0,0,1]
  v_pk_fma_f32 v[146:147], v[130:131], v[182:183], v[146:147] op_sel:[0,1,0] op_sel_hi:[1,1,1]
  v_pk_fma_f32 v[130:131], v[130:131], v[182:183], v[210:211] op_sel_hi:[1,0,1] neg_lo:[0,0,1] neg_hi:[0,0,1]
  s_add_u32 m0, s11, 33792
  s_nop 0
  buffer_load_dwordx4 v253, s[80:83], s26 offen lds
  v_pk_fma_f32 v[148:149], v[132:133], v[182:183], v[148:149] op_sel:[0,1,0] op_sel_hi:[1,1,1]
  v_pk_fma_f32 v[132:133], v[132:133], v[182:183], v[212:213] op_sel_hi:[1,0,1] neg_lo:[0,0,1] neg_hi:[0,0,1]
  v_pk_fma_f32 v[150:151], v[134:135], v[182:183], v[150:151] op_sel:[0,1,0] op_sel_hi:[1,1,1]
  v_pk_fma_f32 v[134:135], v[134:135], v[182:183], v[214:215] op_sel_hi:[1,0,1] neg_lo:[0,0,1] neg_hi:[0,0,1]
  v_pk_fma_f32 v[152:153], v[136:137], v[182:183], v[152:153] op_sel:[0,1,0] op_sel_hi:[1,1,1]
  v_pk_fma_f32 v[136:137], v[136:137], v[182:183], v[216:217] op_sel_hi:[1,0,1] neg_lo:[0,0,1] neg_hi:[0,0,1]
  v_pk_fma_f32 v[154:155], v[138:139], v[182:183], v[154:155] op_sel:[0,1,0] op_sel_hi:[1,1,1]
  v_pk_fma_f32 v[138:139], v[138:139], v[182:183], v[218:219] op_sel_hi:[1,0,1] neg_lo:[0,0,1] neg_hi:[0,0,1]
  v_pk_fma_f32 v[156:157], v[140:141], v[182:183], v[156:157] op_sel:[0,1,0] op_sel_hi:[1,1,1]
  v_pk_fma_f32 v[140:141], v[140:141], v[182:183], v[220:221] op_sel_hi:[1,0,1] neg_lo:[0,0,1] neg_hi:[0,0,1]
  s_add_u32 m0, s11, 34816
  s_nop 0
  buffer_load_dwordx4 v254, s[80:83], s26 offen lds
  v_pk_fma_f32 v[158:159], v[142:143], v[182:183], v[158:159] op_sel:[0,1,0] op_sel_hi:[1,1,1]
  v_pk_fma_f32 v[142:143], v[142:143], v[182:183], v[222:223] op_sel_hi:[1,0,1] neg_lo:[0,0,1] neg_hi:[0,0,1]
  v_fma_f32 v58, v180, v128, v129
  v_fma_f32 v59, v180, v144, v145
  v_fma_f32 v58, -v181, v144, v58
  v_fma_f32 v59, v181, v128, v59
  v_fma_f32 v60, v180, v58, v130
  v_fma_f32 v61, v180, v59, v146
  v_fma_f32 v60, -v181, v59, v60
  v_fma_f32 v61, v181, v58, v61
  v_fma_f32 v58, v180, v60, v131
  v_fma_f32 v59, v180, v61, v147
  v_fma_f32 v58, -v181, v61, v58
  v_fma_f32 v59, v181, v60, v59
  v_fma_f32 v60, v180, v58, v132
  v_fma_f32 v61, v180, v59, v148
  v_fma_f32 v60, -v181, v59, v60
  v_fma_f32 v61, v181, v58, v61
  v_fma_f32 v58, v180, v60, v133
  v_fma_f32 v59, v180, v61, v149
  v_fma_f32 v58, -v181, v61, v58
  v_fma_f32 v59, v181, v60, v59
  v_fma_f32 v60, v180, v58, v134
  v_fma_f32 v61, v180, v59, v150
  v_fma_f32 v60, -v181, v59, v60
  v_fma_f32 v61, v181, v58, v61
  v_fma_f32 v58, v180, v60, v135
  v_fma_f32 v59, v180, v61, v151
  v_fma_f32 v58, -v181, v61, v58
  v_fma_f32 v59, v181, v60, v59
  v_fma_f32 v60, v180, v58, v136
  v_fma_f32 v61, v180, v59, v152
  v_fma_f32 v60, -v181, v59, v60
  v_fma_f32 v61, v181, v58, v61
  v_fma_f32 v58, v180, v60, v137
  v_fma_f32 v59, v180, v61, v153
  v_fma_f32 v58, -v181, v61, v58
  v_fma_f32 v59, v181, v60, v59
  v_fma_f32 v60, v180, v58, v138
  v_fma_f32 v61, v180, v59, v154
  v_fma_f32 v60, -v181, v59, v60
  v_fma_f32 v61, v181, v58, v61
  v_fma_f32 v58, v180, v60, v139
  v_fma_f32 v59, v180, v61, v155
  v_fma_f32 v58, -v181, v61, v58
  v_fma_f32 v59, v181, v60, v59
  v_fma_f32 v60, v180, v58, v140
  v_fma_f32 v61, v180, v59, v156
  v_fma_f32 v60, -v181, v59, v60
  v_fma_f32 v61, v181, v58, v61
  v_fma_f32 v58, v180, v60, v141
  v_fma_f32 v59, v180, v61, v157
  v_fma_f32 v58, -v181, v61, v58
  v_fma_f32 v59, v181, v60, v59
  v_fma_f32 v60, v180, v58, v142
  v_fma_f32 v61, v180, v59, v158
  v_fma_f32 v60, -v181, v59, v60
  v_fma_f32 v61, v181, v58, v61
  v_fma_f32 v58, v180, v60, v143
  v_fma_f32 v59, v180, v61, v159
  v_fma_f32 v58, -v181, v61, v58
  v_fma_f32 v59, v181, v60, v59
  s_lshl_b32 s6, s5, 9
  s_add_u32 s6, s6, 156672
  v_lshl_add_u32 v2, v1, 3, s6
  ds_write_b64 v2, v[58:59]
  s_waitcnt vmcnt(11)
  v_cmp_ne_u32 vcc, v23, v11
  s_nop 1
  s_and_b64 vcc, vcc, s[50:51]
  s_cbranch_scc1 L_lz_29
L_lzr_30:
  s_waitcnt lgkmcnt(0)
  s_barrier
  v_lshlrev_b32 v2, 3, v6
  v_add_u32 v2, 156672, v2
  buffer_load_dwordx4 a[128:131], v33, s[88:91], s28 offen offset:0 sc1
  ds_read_b64 v[96:97], v2 offset:0
  ds_read_b64 v[98:99], v2 offset:256
  ds_read_b64 v[100:101], v2 offset:512
  ds_read_b64 v[102:103], v2 offset:768
  ds_read_b64 v[104:105], v2 offset:1024
  ds_read_b64 v[106:107], v2 offset:1280
  ds_read_b64 v[108:109], v2 offset:1536
  ds_read_b64 v[110:111], v2 offset:1792
  s_lshl_b32 s6, s5, 1
  v_add_u32 v2, s6, v7
  v_mov_b32 v56, 0
  v_mov_b32 v57, 0
  buffer_load_dwordx4 a[132:135], v33, s[88:91], s28 offen offset:1024 sc1
  v_cmp_eq_u32 vcc, 1, v2
  s_waitcnt lgkmcnt(6)
  v_fma_f32 v62, v184, v96, v98
  v_fma_f32 v63, v184, v97, v99
  v_cndmask_b32 v56, v56, v96, vcc
  v_cndmask_b32 v57, v57, v97, vcc
  v_fma_f32 v62, -v185, v97, v62
  v_fma_f32 v63, v185, v96, v63
  v_cmp_eq_u32 vcc, 2, v2
  s_waitcnt lgkmcnt(5)
  v_fma_f32 v60, v184, v62, v100
  v_fma_f32 v61, v184, v63, v101
  v_cndmask_b32 v56, v56, v62, vcc
  v_cndmask_b32 v57, v57, v63, vcc
  buffer_load_dwordx4 a[136:139], v33, s[88:91], s28 offen offset:2048 sc1
  v_fma_f32 v60, -v185, v63, v60
  v_fma_f32 v61, v185, v62, v61
  v_cmp_eq_u32 vcc, 3, v2
  s_waitcnt lgkmcnt(4)
  v_fma_f32 v62, v184, v60, v102
  v_fma_f32 v63, v184, v61, v103
  v_cndmask_b32 v56, v56, v60, vcc
  v_cndmask_b32 v57, v57, v61, vcc
  v_fma_f32 v62, -v185, v61, v62
  v_fma_f32 v63, v185, v60, v63
  buffer_load_dwordx4 a[140:143], v33, s[88:91], s28 offen offset:3072 sc1
  v_cmp_eq_u32 vcc, 4, v2
  s_waitcnt lgkmcnt(3)
  v_fma_f32 v60, v184, v62, v104
  v_fma_f32 v61, v184, v63, v105
  v_cndmask_b32 v56, v56, v62, vcc
  v_cndmask_b32 v57, v57, v63, vcc
  v_fma_f32 v60, -v185, v63, v60
  v_fma_f32 v61, v185, v62, v61
  v_cmp_eq_u32 vcc, 5, v2
  s_waitcnt lgkmcnt(2)
  v_fma_f32 v62, v184, v60, v106
  v_fma_f32 v63, v184, v61, v107
  v_cndmask_b32 v56, v56, v60, vcc
  v_cndmask_b32 v57, v57, v61, vcc
  s_add_u32 s28, s28, 4096
  s_and_b32 s28, s28, 16383
  buffer_load_dwordx4 a[144:147], v33, s[88:91], s28 offen offset:0 sc1
  v_fma_f32 v62, -v185, v61, v62
  v_fma_f32 v63, v185, v60, v63
  v_cmp_eq_u32 vcc, 6, v2
  s_waitcnt lgkmcnt(1)
  v_fma_f32 v60, v184, v62, v108
  v_fma_f32 v61, v184, v63, v109
  v_cndmask_b32 v56, v56, v62, vcc
  v_cndmask_b32 v57, v57, v63, vcc
  v_fma_f32 v60, -v185, v63, v60
  v_fma_f32 v61, v185, v62, v61
  buffer_load_dwordx4 a[148:151], v33, s[88:91], s28 offen offset:1024 sc1
  v_cmp_eq_u32 vcc, 7, v2
  s_waitcnt lgkmcnt(0)
  v_fma_f32 v62, v184, v60, v110
  v_fma_f32 v63, v184, v61, v111
  v_cndmask_b32 v56, v56, v60, vcc
  v_cndmask_b32 v57, v57, v61, vcc
  v_fma_f32 v62, -v185, v61, v62
  v_fma_f32 v63, v185, v60, v63
  v_mov_b32 v96, v62
  v_mov_b32 v97, v11
  v_mov_b32 v98, v63
  v_mov_b32 v99, v11
  buffer_load_dwordx4 a[152:155], v33, s[88:91], s28 offen offset:2048 sc1
  s_lshl_b32 s6, s3, 13
  s_add_u32 s6, s6, s48
  v_lshlrev_b32 v2, 4, v6
  s_cmp_lg_u32 s5, 0
  s_cselect_b32 s6, 0x80000000, s6
  s_mov_b32 exec_hi, 0
  buffer_store_dwordx4 v[96:99], v2, s[88:91], s6 offen sc0 sc1
L_stub3:
  s_cbranch_execz L_stub7
  s_mov_b64 exec, -1
  v_mov_b32 v216, 0x3f803f80
  v_mov_b32 v217, 0x3f803f80
  v_mov_b32 v218, 0x3f803f80
  v_mov_b32 v219, 0x3f803f80
  s_waitcnt vmcnt(8)
  ds_read_b64_tr_b16 v[192:193], v32 offset:0
  ds_read_b64_tr_b16 v[194:195], v32 offset:128
  ds_read_b64_tr_b16 v[196:197], v32 offset:256
  buffer_load_dwordx4 a[156:159], v33, s[88:91], s28 offen offset:3072 sc1
  ds_read_b64_tr_b16 v[198:199], v32 offset:384
  ds_read_b64_tr_b16 v[200:201], v32 offset:512
  ds_read_b64_tr_b16 v[202:203], v32 offset:640
  ds_read_b64_tr_b16 v[204:205], v32 offset:768
  ds_read_b64_tr_b16 v[206:207], v32 offset:896
  s_waitcnt lgkmcnt(6)
  v_mfma_f32_16x16x32_bf16 v[64:67], v[192:195], v[216:219], 0
  ds_read_b64_tr_b16 v[208:209], v32 offset:1024
  ds_read_b64_tr_b16 v[210:211], v32 offset:1152
  buffer_load_dwordx4 v[160:163], v8, s[88:91], s37 offen offset:0 sc1
  s_waitcnt lgkmcnt(6)
  v_mfma_f32_16x16x32_bf16 v[68:71], v[196:199], v[216:219], 0
  ds_read_b64_tr_b16 v[212:213], v32 offset:1280
  ds_read_b64_tr_b16 v[214:215], v32 offset:1408
  s_waitcnt lgkmcnt(6)
  v_mfma_f32_16x16x32_bf16 v[72:75], v[200:203], v[216:219], 0
  ds_read_b64_tr_b16 v[192:193], v32 offset:1536
  ds_read_b64_tr_b16 v[194:195], v32 offset:1664
  buffer_load_dwordx4 v[164:167], v8, s[88:91], s37 offen offset:1024 sc1
  s_waitcnt lgkmcnt(6)
  v_mfma_f32_16x16x32_bf16 v[76:79], v[204:207], v[216:219], 0
  ds_read_b64_tr_b16 v[196:197], v32 offset:28672
  ds_read_b64_tr_b16 v[198:199], v32 offset:28800
  s_waitcnt lgkmcnt(6)
  v_mfma_f32_16x16x32_bf16 v[80:83], v[208:211], v[216:219], 0
  ds_read_b64_tr_b16 v[200:201], v32 offset:28928
  ds_read_b64_tr_b16 v[202:203], v32 offset:29056
  buffer_load_dwordx4 v[168:171], v8, s[88:91], s37 offen offset:2048 sc1
  s_waitcnt lgkmcnt(6)
  v_mfma_f32_16x16x32_bf16 v[84:87], v[212:215], v[216:219], 0
  ds_read_b64_tr_b16 v[204:205], v32 offset:29184
  ds_read_b64_tr_b16 v[206:207], v32 offset:29312
  s_waitcnt lgkmcnt(6)
  v_mfma_f32_16x16x32_bf16 v[88:91], v[192:195], v[216:219], 0
  ds_read_b64_tr_b16 v[208:209], v32 offset:29440
  ds_read_b64_tr_b16 v[210:211], v32 offset:29568
  buffer_load_dwordx4 v[172:175], v8, s[88:91], s37 offen offset:3072 sc1
  s_waitcnt lgkmcnt(6)
  v_mfma_f32_16x16x32_bf16 v[64:67], v[196:199], v[216:219], v[64:67]
  ds_read_b64_tr_b16 v[212:213], v32 offset:29696
  ds_read_b64_tr_b16 v[214:215], v32 offset:29824
  s_waitcnt lgkmcnt(6)
  v_mfma_f32_16x16x32_bf16 v[68:71], v[200:203], v[216:219], v[68:71]
  ds_read_b64_tr_b16 v[192:193], v32 offset:29952
  ds_read_b64_tr_b16 v[194:195], v32 offset:30080
  s_add_u32 s28, s28, 4096
  s_and_b32 s28, s28, 16383
  buffer_load_dwordx4 a[160:163], v33, s[88:91], s28 offen offset:0 sc1
  s_waitcnt lgkmcnt(6)
  v_mfma_f32_16x16x32_bf16 v[72:75], v[204:207], v[216:219], v[72:75]
  ds_read_b64_tr_b16 v[196:197], v32 offset:30208
  ds_read_b64_tr_b16 v[198:199], v32 offset:30336
  s_waitcnt lgkmcnt(6)
  v_mfma_f32_16x16x32_bf16 v[76:79], v[208:211], v[216:219], v[76:79]
  s_waitcnt lgkmcnt(4)
  v_mfma_f32_16x16x32_bf16 v[80:83], v[212:215], v[216:219], v[80:83]
  buffer_load_dwordx4 a[164:167], v33, s[88:91], s28 offen offset:1024 sc1
  s_waitcnt lgkmcnt(2)
  v_mfma_f32_16x16x32_bf16 v[84:87], v[192:195], v[216:219], v[84:87]
  s_waitcnt lgkmcnt(0)
  v_mfma_f32_16x16x32_bf16 v[88:91], v[196:199], v[216:219], v[88:91]
  s_mov_b32 exec_lo, 0x00010001
  s_mov_b32 exec_hi, 0x00010001
  ds_write_b128 v46, v[64:67] offset:2048
  ds_write_b128 v46, v[68:71] offset:2112
  ds_write_b128 v46, v[72:75] offset:2176
  ds_write_b128 v46, v[76:79] offset:2240
  ds_write_b128 v46, v[80:83] offset:2304
  ds_write_b128 v46, v[84:87] offset:2368
  ds_write_b128 v46, v[88:91] offset:2432
  s_mov_b64 exec, -1
  buffer_load_dwordx4 a[168:171], v33, s[88:91], s28 offen offset:2048 sc1
  s_waitcnt lgkmcnt(0)
  s_barrier
  ds_read_b64_tr_b16 v[192:193], v28 offset:0
  ds_read_b64_tr_b16 v[194:195], v29 offset:0
  ds_read_b64_tr_b16 v[196:197], v28 offset:512
  ds_read_b64_tr_b16 v[198:199], v29 offset:512
  ds_read_b64_tr_b16 v[200:201], v28 offset:1024
  ds_read_b64_tr_b16 v[202:203], v29 offset:1024
  s_waitcnt vmcnt(15)
  v_accvgpr_read_b32 v44, a128
  buffer_load_dwordx4 a[172:175], v33, s[88:91], s28 offen offset:3072 sc1
  s_waitcnt vmcnt(15)
  v_accvgpr_read_b32 v45, a132
  v_cmp_u_f32 vcc, v44, v45
  s_cbranch_vccnz L_ck_31
L_ckr_32:
  ds_read_b64_tr_b16 v[204:205], v28 offset:1536
  ds_read_b64_tr_b16 v[206:207], v29 offset:1536
  s_waitcnt lgkmcnt(6)
  v_mfma_f32_32x32x16_bf16 v[64:79], v[192:195], a[128:131], 0
  ds_read_b64_tr_b16 v[208:209], v28 offset:3584
  s_add_u32 s28, s28, 4096
  s_and_b32 s28, s28, 16383
  buffer_load_dwordx4 a[176:179], v33, s[88:91], s28 offen offset:0 sc1
  ds_read_b64_tr_b16 v[210:211], v29 offset:3584
  s_waitcnt vmcnt(7)
  v_max3_u32 v16, v160, v162, v164
  s_waitcnt vmcnt(6)
  v_max3_u32 v16, v16, v166, v168
  s_waitcnt vmcnt(5)
  v_max3_u32 v16, v16, v170, v172
  v_cmp_u_f32 vcc, v16, v174
  s_mov_b32 s13, 0
  s_nop 0
  s_cbranch_vccnz L_sp_33
L_spd_34:
  buffer_load_dwordx4 a[180:183], v33, s[88:91], s28 offen offset:1024 sc1
  s_waitcnt lgkmcnt(6)
  v_mfma_f32_32x32x16_bf16 v[80:95], v[196:199], a[128:131], 0
  ds_read_b64_tr_b16 v[212:213], v28 offset:4096
  ds_read_b64_tr_b16 v[214:215], v29 offset:4096
  v_add_f32 v160, v160, v164
  v_add_f32 v161, v161, v165
  v_add_f32 v162, v162, v166
  v_add_f32 v163, v163, v167
  v_add_f32 v168, v168, v172
  buffer_load_dwordx4 a[184:187], v33, s[88:91], s28 offen offset:2048 sc1
  v_add_f32 v169, v169, v173
  v_add_f32 v170, v170, v174
  v_add_f32 v171, v171, v175
  v_add_f32 v160, v160, v168
  v_add_f32 v161, v161, v169
  v_add_f32 v162, v162, v170
  s_waitcnt lgkmcnt(6)
  v_mfma_f32_32x32x16_bf16 v[96:111], v[200:203], a[128:131], 0
  ds_read_b64_tr_b16 v[192:193], v28 offset:4608
  buffer_load_dwordx4 a[188:191], v33, s[88:91], s28 offen offset:3072 sc1
  ds_read_b64_tr_b16 v[194:195], v29 offset:4608
  v_add_f32 v163, v163, v171
  v_add_f32 v160, v160, v162
  v_add_f32 v161, v161, v163
  v_mov_b32 v162, v160
  v_mov_b32 v163, v161
  s_nop 0
  v_permlane32_swap_b32 v160, v162
  v_permlane32_swap_b32 v161, v163
  v_add_f32 v160, v160, v162
  s_add_u32 m0, s11, 69632
  s_add_u32 s26, s20, 0
  s_and_b32 s26, s26, 7
  s_add_u32 s26, s26, 8
  s_mul_i32 s26, s26, 114688
  buffer_load_dwordx4 v176, s[80:83], s26 offen lds
  s_waitcnt lgkmcnt(6)
  v_mfma_f32_32x32x16_bf16 v[112:127], v[204:207], a[128:131], 0
  ds_read_b64_tr_b16 v[196:197], v28 offset:5120
  ds_read_b64_tr_b16 v[198:199], v29 offset:5120
  v_add_f32 v161, v161, v163
  v_mul_f32 v160, 0x3b000000, v160
  v_mul_f32 v161, 0x3b000000, v161
  v_fma_f32 v161, -v160, v160, v161
  v_max_f32 v161, 0, v161
  s_add_u32 m0, s11, 70656
  s_nop 0
  buffer_load_dwordx4 v177, s[80:83], s26 offen lds
  v_cvt_pk_bf16_f32 v162, v160, v161
  v_and_b32 v163, v10, v162
  v_add_f32 v163, 0x3727c5ac, v163
  v_cvt_pk_bf16_f32 v163, v163, v163
  v_and_b32 v163, v10, v163
  s_waitcnt lgkmcnt(6)
  v_mfma_f32_32x32x16_bf16 v[64:79], v[208:211], a[132:135], v[64:79]
  ds_read_b64_tr_b16 v[200:201], v28 offset:7168
  ds_read_b64_tr_b16 v[202:203], v29 offset:7168
  s_add_u32 m0, s11, 71680
  s_nop 0
  buffer_load_dwordx4 v178, s[80:83], s26 offen lds
  v_accvgpr_read_b32 v44, a136
  v_sqrt_f32 v163, v163
  s_nop 0
  v_cvt_pk_bf16_f32 v163, v163, v163
  v_and_b32 v63, v10, v163
  v_rcp_f32 v164, v63
  v_lshlrev_b32 v62, 16, v162
  v_xor_b32 v62, 0x80000000, v62
  s_add_u32 m0, s11, 72704
  s_nop 0
  buffer_load_dwordx4 v179, s[80:83], s26 offen lds
  s_waitcnt lgkmcnt(6)
  v_mfma_f32_32x32x16_bf16 v[80:95], v[212:215], a[132:135], v[80:95]
  ds_read_b64_tr_b16 v[204:205], v28 offset:7680
  ds_read_b64_tr_b16 v[206:207], v29 offset:7680
  v_accvgpr_read_b32 v45, a140
  v_mul_f32 v60, 0xc0135761, v164
  v_mul_f32 v165, v164, v164
  v_mul_f32 v164, 0xbdd2d3e8, v164
  v_mul_f32 v61, v164, v165
  s_add_u32 m0, s11, 73728
  s_nop 0
  buffer_load_dwordx4 v252, s[80:83], s26 offen lds
  s_waitcnt lgkmcnt(6)
  v_mfma_f32_32x32x16_bf16 v[96:111], v[192:195], a[132:135], v[96:111]
  ds_read_b64_tr_b16 v[208:209], v28 offset:8192
  ds_read_b64_tr_b16 v[210:211], v29 offset:8192
  v_cmp_u_f32 vcc, v44, v45
  s_cbranch_vccnz L_ck_35
L_ckr_36:
  s_waitcnt lgkmcnt(6)
  v_mfma_f32_32x32x16_bf16 v[112:127], v[196:199], a[132:135], v[112:127]
  ds_read_b64_tr_b16 v[212:213], v28 offset:8704
  s_add_u32 m0, s11, 74752
  s_nop 0
  buffer_load_dwordx4 v253, s[80:83], s26 offen lds
  ds_read_b64_tr_b16 v[214:215], v29 offset:8704
  s_waitcnt lgkmcnt(6)
  v_mfma_f32_32x32x16_bf16 v[64:79], v[200:203], a[136:139], v[64:79]
  ds_read_b64_tr_b16 v[192:193], v28 offset:10752
  ds_read_b64_tr_b16 v[194:195], v29 offset:10752
  s_waitcnt lgkmcnt(6)
  v_mfma_f32_32x32x16_bf16 v[80:95], v[204:207], a[136:139], v[80:95]
  ds_read_b64_tr_b16 v[196:197], v28 offset:11264
  s_add_u32 m0, s11, 75776
  s_nop 0
  buffer_load_dwordx4 v254, s[80:83], s26 offen lds
  ds_read_b64_tr_b16 v[198:199], v29 offset:11264
  s_waitcnt lgkmcnt(6)
  v_mfma_f32_32x32x16_bf16 v[96:111], v[208:211], a[136:139], v[96:111]
  ds_read_b64_tr_b16 v[200:201], v28 offset:11776
  ds_read_b64_tr_b16 v[202:203], v29 offset:11776
  s_waitcnt lgkmcnt(6)
  v_mfma_f32_32x32x16_bf16 v[112:127], v[212:215], a[136:139], v[112:127]
  ds_read_b64_tr_b16 v[204:205], v28 offset:12288
  s_add_u32 m0, s11, 98304
  s_add_u32 s26, s20, 4
  s_and_b32 s26, s26, 7
  s_add_u32 s26, s26, 8
  s_mul_i32 s26, s26, 114688
  buffer_load_dwordx4 v176, s[80:83], s26 offen lds
  ds_read_b64_tr_b16 v[206:207], v29 offset:12288
  s_waitcnt lgkmcnt(6)
  v_mfma_f32_32x32x16_bf16 v[64:79], v[192:195], a[140:143], v[64:79]
  ds_read_b64_tr_b16 v[208:209], v28 offset:14336
  ds_read_b64_tr_b16 v[210:211], v29 offset:14336
  v_accvgpr_read_b32 v44, a144
  s_waitcnt lgkmcnt(6)
  v_mfma_f32_32x32x16_bf16 v[80:95], v[196:199], a[140:143], v[80:95]
  ds_read_b64_tr_b16 v[212:213], v28 offset:14848
  s_add_u32 m0, s11, 99328
  s_nop 0
  buffer_load_dwordx4 v177, s[80:83], s26 offen lds
  ds_read_b64_tr_b16 v[214:215], v29 offset:14848
  v_accvgpr_read_b32 v45, a148
  s_waitcnt lgkmcnt(6)
  v_mfma_f32_32x32x16_bf16 v[96:111], v[200:203], a[140:143], v[96:111]
  ds_read_b64_tr_b16 v[192:193], v28 offset:15360
  ds_read_b64_tr_b16 v[194:195], v29 offset:15360
  v_cmp_u_f32 vcc, v44, v45
  s_cbranch_vccnz L_ck_37
L_ckr_38:
  s_waitcnt lgkmcnt(6)
  v_mfma_f32_32x32x16_bf16 v[112:127], v[204:207], a[140:143], v[112:127]
  ds_read_b64_tr_b16 v[196:197], v28 offset:15872
  s_add_u32 m0, s11, 100352
  s_nop 0
  buffer_load_dwordx4 v178, s[80:83], s26 offen lds
  ds_read_b64_tr_b16 v[198:199], v29 offset:15872
  s_waitcnt lgkmcnt(6)
  v_mfma_f32_32x32x16_bf16 v[64:79], v[208:211], a[144:147], v[64:79]
  ds_read_b64_tr_b16 v[200:201], v28 offset:17920
  ds_read_b64_tr_b16 v[202:203], v29 offset:17920
  s_waitcnt lgkmcnt(6)
  v_mfma_f32_32x32x16_bf16 v[80:95], v[212:215], a[144:147], v[80:95]
  ds_read_b64_tr_b16 v[204:205], v28 offset:18432
  s_add_u32 m0, s11, 101376
  s_nop 0
  buffer_load_dwordx4 v179, s[80:83], s26 offen lds
  ds_read_b64_tr_b16 v[206:207], v29 offset:18432
  s_waitcnt lgkmcnt(6)
  v_mfma_f32_32x32x16_bf16 v[96:111], v[192:195], a[144:147], v[96:111]
  ds_read_b64_tr_b16 v[208:209], v28 offset:18944
  ds_read_b64_tr_b16 v[210:211], v29 offset:18944
  s_waitcnt lgkmcnt(6)
  v_mfma_f32_32x32x16_bf16 v[112:127], v[196:199], a[144:147], v[112:127]
  ds_read_b64_tr_b16 v[212:213], v28 offset:19456
  s_add_u32 m0, s11, 102400
  s_nop 0
  buffer_load_dwordx4 v252, s[80:83], s26 offen lds
  ds_read_b64_tr_b16 v[214:215], v29 offset:19456
  s_waitcnt lgkmcnt(6)
  v_mfma_f32_32x32x16_bf16 v[64:79], v[200:203], a[148:151], v[64:79]
  ds_read_b64_tr_b16 v[192:193], v28 offset:21504
  ds_read_b64_tr_b16 v[194:195], v29 offset:21504
  v_accvgpr_read_b32 v44, a152
  s_waitcnt lgkmcnt(6)
  v_mfma_f32_32x32x16_bf16 v[80:95], v[204:207], a[148:151], v[80:95]
  ds_read_b64_tr_b16 v[196:197], v28 offset:22016
  s_add_u32 m0, s11, 103424
  s_nop 0
  buffer_load_dwordx4 v253, s[80:83], s26 offen lds
  ds_read_b64_tr_b16 v[198:199], v29 offset:22016
  v_accvgpr_read_b32 v45, a156
  s_waitcnt lgkmcnt(6)
  v_mfma_f32_32x32x16_bf16 v[96:111], v[208:211], a[148:151], v[96:111]
  ds_read_b64_tr_b16 v[200:201], v28 offset:22528
  ds_read_b64_tr_b16 v[202:203], v29 offset:22528
  v_cmp_u_f32 vcc, v44, v45
  s_cbranch_vccnz L_ck_39
L_ckr_40:
  s_waitcnt lgkmcnt(6)
  v_mfma_f32_32x32x16_bf16 v[112:127], v[212:215], a[148:151], v[112:127]
  ds_read_b64_tr_b16 v[204:205], v28 offset:23040
  s_add_u32 m0, s11, 104448
  s_nop 0
  buffer_load_dwordx4 v254, s[80:83], s26 offen lds
  ds_read_b64_tr_b16 v[206:207], v29 offset:23040
  s_waitcnt lgkmcnt(6)
  v_mfma_f32_32x32x16_bf16 v[64:79], v[192:195], a[152:155], v[64:79]
  ds_read_b64_tr_b16 v[208:209], v28 offset:25088
  ds_read_b64_tr_b16 v[210:211], v29 offset:25088
  s_waitcnt lgkmcnt(6)
  v_mfma_f32_32x32x16_bf16 v[80:95], v[196:199], a[152:155], v[80:95]
  ds_read_b64_tr_b16 v[212:213], v28 offset:25600
  buffer_load_dword v19, v20, s[88:91], 0 offen sc1
  ds_read_b64_tr_b16 v[214:215], v29 offset:25600
  s_waitcnt lgkmcnt(6)
  v_mfma_f32_32x32x16_bf16 v[96:111], v[200:203], a[152:155], v[96:111]
  ds_read_b64_tr_b16 v[192:193], v28 offset:26112
  ds_read_b64_tr_b16 v[194:195], v29 offset:26112
  s_waitcnt lgkmcnt(6)
  v_mfma_f32_32x32x16_bf16 v[112:127], v[204:207], a[152:155], v[112:127]
  ds_read_b64_tr_b16 v[196:197], v28 offset:26624
  s_add_u32 s28, s28, 4096
  s_and_b32 s28, s28, 16383
  v_add_u32 v33, 0x4000, v33
  buffer_load_dwordx4 a[192:195], v33, s[88:91], s28 offen offset:0 sc1
  ds_read_b64_tr_b16 v[198:199], v29 offset:26624
  s_waitcnt lgkmcnt(6)
  v_mfma_f32_32x32x16_bf16 v[64:79], v[208:211], a[156:159], v[64:79]
  ds_read_b64_tr_b16 v[200:201], v28 offset:28672
  ds_read_b64_tr_b16 v[202:203], v29 offset:28672
  s_waitcnt vmcnt(23)
  v_accvgpr_read_b32 v44, a160
  s_waitcnt lgkmcnt(6)
  v_mfma_f32_32x32x16_bf16 v[80:95], v[212:215], a[156:159], v[80:95]
  ds_read_b64_tr_b16 v[204:205], v28 offset:29184
  buffer_load_dwordx4 a[196:199], v33, s[88:91], s28 offen offset:1024 sc1
  ds_read_b64_tr_b16 v[206:207], v29 offset:29184
  s_waitcnt vmcnt(23)
  v_accvgpr_read_b32 v45, a164
  s_waitcnt lgkmcnt(6)
  v_mfma_f32_32x32x16_bf16 v[96:111], v[192:195], a[156:159], v[96:111]
  ds_read_b64_tr_b16 v[208:209], v28 offset:29696
  ds_read_b64_tr_b16 v[210:211], v29 offset:29696
  v_cmp_u_f32 vcc, v44, v45
  s_cbranch_vccnz L_ck_41
L_ckr_42:
  buffer_load_dwordx4 a[200:203], v33, s[88:91], s28 offen offset:2048 sc1
  s_waitcnt lgkmcnt(6)
  v_mfma_f32_32x32x16_bf16 v[112:127], v[196:199], a[156:159], v[112:127]
  ds_read_b64_tr_b16 v[212:213], v28 offset:30208
  ds_read_b64_tr_b16 v[214:215], v29 offset:30208
  s_waitcnt lgkmcnt(6)
  v_mfma_f32_32x32x16_bf16 v[64:79], v[200:203], a[160:163], v[64:79]
  ds_read_b64_tr_b16 v[192:193], v28 offset:32256
  buffer_load_dwordx4 a[204:207], v33, s[88:91], s28 offen offset:3072 sc1
  ds_read_b64_tr_b16 v[194:195], v29 offset:32256
  s_waitcnt lgkmcnt(6)
  v_mfma_f32_32x32x16_bf16 v[80:95], v[204:207], a[160:163], v[80:95]
  ds_read_b64_tr_b16 v[196:197], v28 offset:32768
  ds_read_b64_tr_b16 v[198:199], v29 offset:32768
  s_waitcnt lgkmcnt(6)
  v_mfma_f32_32x32x16_bf16 v[96:111], v[208:211], a[160:163], v[96:111]
  v_subrev_u32 v5, 0, v18
  buffer_load_dwordx4 v[220:223], v5, s[88:91], s48 offen sc1
  ds_read_b64_tr_b16 v[200:201], v28 offset:33280
  ds_read_b64_tr_b16 v[202:203], v29 offset:33280
  s_waitcnt lgkmcnt(6)
  v_mfma_f32_32x32x16_bf16 v[112:127], v[212:215], a[160:163], v[112:127]
  ds_read_b64_tr_b16 v[204:205], v28 offset:33792
  ds_read_b64_tr_b16 v[206:207], v29 offset:33792
  s_waitcnt lgkmcnt(6)
  v_mfma_f32_32x32x16_bf16 v[64:79], v[192:195], a[164:167], v[64:79]
  ds_read_b64_tr_b16 v[208:209], v28 offset:35840
  v_subrev_u32 v5, 16384, v18
  buffer_load_dwordx4 v[224:227], v5, s[88:91], s48 offen sc1
  ds_read_b64_tr_b16 v[210:211], v29 offset:35840
  s_waitcnt vmcnt(26)
  v_accvgpr_read_b32 v44, a168
  s_waitcnt lgkmcnt(6)
  v_mfma_f32_32x32x16_bf16 v[80:95], v[196:199], a[164:167], v[80:95]
  ds_read_b64_tr_b16 v[212:213], v28 offset:36352
  ds_read_b64_tr_b16 v[214:215], v29 offset:36352
  s_waitcnt vmcnt(25)
  v_accvgpr_read_b32 v45, a172
  v_subrev_u32 v5, 32768, v18
  buffer_load_dwordx4 v[228:231], v5, s[88:91], s48 offen sc1
  s_waitcnt lgkmcnt(6)
  v_mfma_f32_32x32x16_bf16 v[96:111], v[200:203], a[164:167], v[96:111]
  ds_read_b64_tr_b16 v[192:193], v28 offset:36864
  ds_read_b64_tr_b16 v[194:195], v29 offset:36864
  v_cmp_u_f32 vcc, v44, v45
  s_cbranch_vccnz L_ck_43
L_ckr_44:
  s_waitcnt lgkmcnt(6)
  v_mfma_f32_32x32x16_bf16 v[112:127], v[204:207], a[164:167], v[112:127]
  ds_read_b64_tr_b16 v[196:197], v28 offset:37376
  v_subrev_u32 v5, 49152, v18
  buffer_load_dwordx4 v[232:235], v5, s[88:91], s48 offen sc1
  ds_read_b64_tr_b16 v[198:199], v29 offset:37376
  s_waitcnt lgkmcnt(6)
  v_mfma_f32_32x32x16_bf16 v[64:79], v[208:211], a[168:171], v[64:79]
  ds_read_b64_tr_b16 v[200:201], v28 offset:39424
  ds_read_b64_tr_b16 v[202:203], v29 offset:39424
  s_waitcnt lgkmcnt(6)
  v_mfma_f32_32x32x16_bf16 v[80:95], v[212:215], a[168:171], v[80:95]
  ds_read_b64_tr_b16 v[204:205], v28 offset:39936
  v_subrev_u32 v5, 65536, v18
  buffer_load_dwordx4 v[236:239], v5, s[88:91], s48 offen sc1
  ds_read_b64_tr_b16 v[206:207], v29 offset:39936
  s_waitcnt lgkmcnt(6)
  v_mfma_f32_32x32x16_bf16 v[96:111], v[192:195], a[168:171], v[96:111]
  ds_read_b64_tr_b16 v[208:209], v28 offset:40448
  ds_read_b64_tr_b16 v[210:211], v29 offset:40448
  s_waitcnt lgkmcnt(6)
  v_mfma_f32_32x32x16_bf16 v[112:127], v[196:199], a[168:171], v[112:127]
  ds_read_b64_tr_b16 v[212:213], v28 offset:40960
  v_subrev_u32 v5, 81920, v18
  buffer_load_dwordx4 v[240:243], v5, s[88:91], s48 offen sc1
  ds_read_b64_tr_b16 v[214:215], v29 offset:40960
  s_waitcnt lgkmcnt(6)
  v_mfma_f32_32x32x16_bf16 v[64:79], v[200:203], a[172:175], v[64:79]
  ds_read_b64_tr_b16 v[192:193], v28 offset:43008
  ds_read_b64_tr_b16 v[194:195], v29 offset:43008
  s_waitcnt vmcnt(28)
  v_accvgpr_read_b32 v44, a176
  s_waitcnt lgkmcnt(6)
  v_mfma_f32_32x32x16_bf16 v[80:95], v[204:207], a[172:175], v[80:95]
  ds_read_b64_tr_b16 v[196:197], v28 offset:43520
  v_subrev_u32 v5, 98304, v18
  buffer_load_dwordx4 v[244:247], v5, s[88:91], s48 offen sc1
  ds_read_b64_tr_b16 v[198:199], v29 offset:43520
  s_waitcnt vmcnt(28)
  v_accvgpr_read_b32 v45, a180
  s_waitcnt lgkmcnt(6)
  v_mfma_f32_32x32x16_bf16 v[96:111], v[208:211], a[172:175], v[96:111]
  ds_read_b64_tr_b16 v[200:201], v28 offset:44032
  ds_read_b64_tr_b16 v[202:203], v29 offset:44032
  v_cmp_u_f32 vcc, v44, v45
  s_cbranch_vccnz L_ck_45
L_ckr_46:
  v_subrev_u32 v5, 114688, v18
  buffer_load_dwordx4 v[248:251], v5, s[88:91], s48 offen sc1
  s_waitcnt lgkmcnt(6)
  v_mfma_f32_32x32x16_bf16 v[112:127], v[212:215], a[172:175], v[112:127]
  ds_read_b64_tr_b16 v[204:205], v28 offset:44544
  ds_read_b64_tr_b16 v[206:207], v29 offset:44544
  s_waitcnt lgkmcnt(6)
  v_mfma_f32_32x32x16_bf16 v[64:79], v[192:195], a[176:179], v[64:79]
  s_waitcnt vmcnt(12)
  v_cmp_ne_u32 vcc, v19, v11
  s_mov_b32 s13, 0
  s_nop 0
  s_cbranch_vccnz L_wtf_47
L_wtfd_48:
  s_add_u32 s28, s28, 4096
  s_and_b32 s28, s28, 16383
  buffer_load_dwordx4 a[208:211], v33, s[88:91], s28 offen offset:0 sc1
  ds_read_b64_tr_b16 v[208:209], v28 offset:46592
  ds_read_b64_tr_b16 v[210:211], v29 offset:46592
  s_waitcnt lgkmcnt(6)
  v_mfma_f32_32x32x16_bf16 v[80:95], v[196:199], a[176:179], v[80:95]
  ds_read_b64_tr_b16 v[212:213], v28 offset:47104
  ds_read_b64_tr_b16 v[214:215], v29 offset:47104
  s_waitcnt lgkmcnt(6)
  v_mfma_f32_32x32x16_bf16 v[96:111], v[200:203], a[176:179], v[96:111]
  ds_read_b64_tr_b16 v[192:193], v28 offset:47616
  buffer_load_dwordx4 a[212:215], v33, s[88:91], s28 offen offset:1024 sc1
  ds_read_b64_tr_b16 v[194:195], v29 offset:47616
  s_waitcnt lgkmcnt(6)
  v_mfma_f32_32x32x16_bf16 v[112:127], v[204:207], a[176:179], v[112:127]
  ds_read_b64_tr_b16 v[196:197], v28 offset:48128
  ds_read_b64_tr_b16 v[198:199], v29 offset:48128
  s_waitcnt lgkmcnt(6)
  v_mfma_f32_32x32x16_bf16 v[64:79], v[208:211], a[180:183], v[64:79]
  ds_read_b64_tr_b16 v[200:201], v28 offset:50176
  buffer_load_dwordx4 a[216:219], v33, s[88:91], s28 offen offset:2048 sc1
  ds_read_b64_tr_b16 v[202:203], v29 offset:50176
  v_accvgpr_read_b32 v44, a184
  s_waitcnt lgkmcnt(6)
  v_mfma_f32_32x32x16_bf16 v[80:95], v[212:215], a[180:183], v[80:95]
  ds_read_b64_tr_b16 v[204:205], v28 offset:50688
  ds_read_b64_tr_b16 v[206:207], v29 offset:50688
  v_accvgpr_read_b32 v45, a188
  s_waitcnt lgkmcnt(6)
  v_mfma_f32_32x32x16_bf16 v[96:111], v[192:195], a[180:183], v[96:111]
  ds_read_b64_tr_b16 v[208:209], v28 offset:51200
  buffer_load_dwordx4 a[220:223], v33, s[88:91], s28 offen offset:3072 sc1
  ds_read_b64_tr_b16 v[210:211], v29 offset:51200
  v_cmp_u_f32 vcc, v44, v45
  s_cbranch_vccnz L_ck_49
L_ckr_50:
  s_waitcnt lgkmcnt(6)
  v_mfma_f32_32x32x16_bf16 v[112:127], v[196:199], a[180:183], v[112:127]
  ds_read_b64_tr_b16 v[212:213], v28 offset:51712
  ds_read_b64_tr_b16 v[214:215], v29 offset:51712
  v_mov_b32 v2, 0
  v_cmp_le_i32 vcc, 0, v18
  s_waitcnt vmcnt(11)
  v_xor_b32 v4, v221, v223
  v_cndmask_b32 v16, 0, v11, vcc
  v_xor_b32 v3, v221, v16
  v_or3_b32 v2, v2, v3, v4
  s_add_u32 s28, s28, 4096
  s_and_b32 s28, s28, 16383
  buffer_load_dwordx4 a[224:227], v33, s[88:91], s28 offen offset:0 sc1
  v_cmp_le_i32 vcc, 16384, v18
  s_waitcnt vmcnt(11)
  v_xor_b32 v4, v225, v227
  v_cndmask_b32 v16, 0, v11, vcc
  v_xor_b32 v3, v225, v16
  v_or3_b32 v2, v2, v3, v4
  s_waitcnt lgkmcnt(6)
  v_mfma_f32_32x32x16_bf16 v[64:79], v[200:203], a[184:187], v[64:79]
  ds_read_b64_tr_b16 v[192:193], v28 offset:53760
  buffer_load_dwordx4 a[228:231], v33, s[88:91], s28 offen offset:1024 sc1
  ds_read_b64_tr_b16 v[194:195], v29 offset:53760
  v_cmp_le_i32 vcc, 32768, v18
  s_waitcnt vmcnt(11)
  v_xor_b32 v4, v229, v231
  v_cndmask_b32 v16, 0, v11, vcc
  v_xor_b32 v3, v229, v16
  v_or3_b32 v2, v2, v3, v4
  v_cmp_le_i32 vcc, 49152, v18
  s_waitcnt vmcnt(10)
  v_xor_b32 v4, v233, v235
  v_cndmask_b32 v16, 0, v11, vcc
  v_xor_b32 v3, v233, v16
  v_or3_b32 v2, v2, v3, v4
  buffer_load_dwordx4 a[232:235], v33, s[88:91], s28 offen offset:2048 sc1
  s_waitcnt lgkmcnt(6)
  v_mfma_f32_32x32x16_bf16 v[80:95], v[204:207], a[184:187], v[80:95]
  ds_read_b64_tr_b16 v[196:197], v28 offset:54272
  ds_read_b64_tr_b16 v[198:199], v29 offset:54272
  v_cmp_le_i32 vcc, 65536, v18
  s_waitcnt vmcnt(10)
  v_xor_b32 v4, v237, v239
  v_cndmask_b32 v16, 0, v11, vcc
  v_xor_b32 v3, v237, v16
  v_or3_b32 v2, v2, v3, v4
  buffer_load_dwordx4 a[236:239], v33, s[88:91], s28 offen offset:3072 sc1
  v_cmp_le_i32 vcc, 81920, v18
  s_waitcnt vmcnt(10)
  v_xor_b32 v4, v241, v243
  v_cndmask_b32 v16, 0, v11, vcc
  v_xor_b32 v3, v241, v16
  v_or3_b32 v2, v2, v3, v4
  s_waitcnt lgkmcnt(6)
  v_mfma_f32_32x32x16_bf16 v[96:111], v[208:211], a[184:187], v[96:111]
  ds_read_b64_tr_b16 v[200:201], v28 offset:54784
  s_add_u32 s28, s28, 4096
  s_and_b32 s28, s28, 16383
  buffer_load_dwordx4 a[240:243], v33, s[88:91], s28 offen offset:0 sc1
  ds_read_b64_tr_b16 v[202:203], v29 offset:54784
  v_cmp_le_i32 vcc, 98304, v18
  s_waitcnt vmcnt(10)
  v_xor_b32 v4, v245, v247
  v_cndmask_b32 v16, 0, v11, vcc
  v_xor_b32 v3, v245, v16
  v_or3_b32 v2, v2, v3, v4
  v_cmp_le_i32 vcc, 114688, v18
  s_waitcnt vmcnt(9)
  v_xor_b32 v4, v249, v251
  v_cndmask_b32 v16, 0, v11, vcc
  v_xor_b32 v3, v249, v16
  v_or3_b32 v2, v2, v3, v4
  buffer_load_dwordx4 a[244:247], v33, s[88:91], s28 offen offset:1024 sc1
  s_waitcnt lgkmcnt(6)
  v_mfma_f32_32x32x16_bf16 v[112:127], v[212:215], a[184:187], v[112:127]
  ds_read_b64_tr_b16 v[204:205], v28 offset:55296
  ds_read_b64_tr_b16 v[206:207], v29 offset:55296
  v_cmp_ne_u32 vcc, 0, v2
  s_mov_b32 s13, 0
  s_nop 0
  s_cbranch_vccnz L_egslow
L_egok:
  v_fma_f32 v184, v190, v248, v244
  buffer_load_dwordx4 a[248:251], v33, s[88:91], s28 offen offset:2048 sc1
  v_fma_f32 v185, v190, v250, v246
  v_fma_f32 v184, -v191, v250, v184
  v_fma_f32 v185, v191, v248, v185
  v_fma_f32 v58, v190, v184, v240
  v_fma_f32 v59, v190, v185, v242
  v_fma_f32 v58, -v191, v185, v58
  s_waitcnt lgkmcnt(6)
  v_mfma_f32_32x32x16_bf16 v[64:79], v[192:195], a[188:191], v[64:79]
  s_barrier
  buffer_load_dwordx4 a[252:255], v33, s[88:91], s28 offen offset:3072 sc1
  ds_read_b64_tr_b16 v[208:209], v30 offset:0
  ds_read_b64_tr_b16 v[210:211], v31 offset:0
  v_accvgpr_read_b32 v44, a192
  v_fma_f32 v59, v191, v184, v59
  v_fma_f32 v184, v190, v58, v236
  v_fma_f32 v185, v190, v59, v238
  v_fma_f32 v184, -v191, v59, v184
  v_fma_f32 v185, v191, v58, v185
  v_fma_f32 v58, v190, v184, v232
  v_fma_f32 v59, v190, v185, v234
  s_mov_b32 m0, s36
  s_nop 0
  buffer_load_dwordx4 v9, s[88:91], s31 offen offset:0 lds
  v_fma_f32 v58, -v191, v185, v58
  s_waitcnt lgkmcnt(6)
  v_mfma_f32_32x32x16_bf16 v[80:95], v[196:199], a[188:191], v[80:95]
  ds_read_b64_tr_b16 v[176:177], v35 offset:0
  ds_read_b64_tr_b16 v[178:179], v35 offset:128
  ds_read_b64_tr_b16 v[212:213], v30 offset:512
  ds_read_b64_tr_b16 v[214:215], v31 offset:512
  v_accvgpr_read_b32 v45, a196
  v_fma_f32 v59, v191, v184, v59
  s_add_u32 m0, s36, 0
  s_nop 0
  buffer_load_dwordx4 v9, s[88:91], s31 offen offset:1024 lds
  v_fma_f32 v184, v190, v58, v228
  v_fma_f32 v185, v190, v59, v230
  v_fma_f32 v184, -v191, v59, v184
  v_fma_f32 v185, v191, v58, v185
L_stub4:
  s_cbranch_execz L_stubret
  v_fma_f32 v58, v190, v184, v224
  v_fma_f32 v59, v190, v185, v226
  v_fma_f32 v58, -v191, v185, v58
  s_waitcnt lgkmcnt(8)
  v_mfma_f32_32x32x16_bf16 v[96:111], v[200:203], a[188:191], v[96:111]
  s_add_u32 m0, s36, 6144
  s_nop 0
  buffer_load_dwordx4 v9, s[88:91], s31 offen offset:2048 lds
  v_fma_f32 v59, v191, v184, v59
  v_fma_f32 v184, v190, v58, v220
  v_fma_f32 v185, v190, v59, v222
  v_fma_f32 v184, -v191, v59, v184
  v_fma_f32 v185, v191, v58, v185
  v_mov_b32 v58, v184
  v_mov_b32 v59, v185
  s_nop 0
  v_permlane32_swap_b32 v58, v184
  v_permlane32_swap_b32 v59, v185
  s_add_u32 m0, s36, 6144
  s_nop 0
  buffer_load_dwordx4 v9, s[88:91], s31 offen offset:3072 lds
  s_waitcnt lgkmcnt(2)
  v_mfma_f32_16x16x32_bf16 v[160:163], v[176:179], v[216:219], 0
  ds_read_b64_tr_b16 v[252:253], v35 offset:28672
  ds_read_b64_tr_b16 v[254:255], v35 offset:28800
  ds_read_b64_tr_b16 v[192:193], v30 offset:1024
  ds_read_b64_tr_b16 v[194:195], v31 offset:1024
  v_cmp_u_f32 vcc, v44, v45
  s_cbranch_vccnz L_ck_51
L_ckr_52:
  v_fmac_f32 v58, v186, v184
  s_add_u32 s31, s31, 4096
  s_cmp_eq_u32 s31, 24576
  s_cselect_b32 s31, 0, s31
  s_add_u32 m0, s36, 16384
  s_nop 0
  buffer_load_dwordx4 v9, s[88:91], s31 offen offset:0 lds
  v_mfma_f32_32x32x16_bf16 v[112:127], v[204:207], a[188:191], v[112:127]
  ds_read_b64_tr_b16 v[196:197], v30 offset:1536
  ds_read_b64_tr_b16 v[198:199], v31 offset:1536
  v_fmac_f32 v59, v186, v185
  v_fma_f32 v58, -v187, v185, v58
  v_fmac_f32 v59, v187, v184
  v_fmac_f32 v56, v188, v58
  v_fmac_f32 v57, v188, v59
  v_fma_f32 v56, -v189, v59, v56
  s_add_u32 m0, s36, 16384
  s_nop 0
  buffer_load_dwordx4 v9, s[88:91], s31 offen offset:1024 lds
  v_fmac_f32 v57, v189, v58
  v_fma_f32 v58, v180, v56, v128
  v_fma_f32 v59, v180, v57, v144
  v_fma_f32 v128, -v181, v57, v58
  v_fma_f32 v144, v181, v56, v59
  v_mfma_f32_32x32x16_bf16 v[64:79], v[208:211], a[192:195], v[64:79]
  v_fma_f32 v58, v180, v128, v129
  v_fma_f32 v59, v180, v144, v145
  v_fma_f32 v129, -v181, v144, v58
  s_add_u32 m0, s36, 22528
  s_nop 0
  buffer_load_dwordx4 v9, s[88:91], s31 offen offset:2048 lds
  v_fma_f32 v145, v181, v128, v59
  v_fma_f32 v58, v180, v129, v130
  v_fma_f32 v59, v180, v145, v146
  v_fma_f32 v130, -v181, v145, v58
  v_fma_f32 v146, v181, v129, v59
  v_fma_f32 v58, v180, v130, v131
  v_fma_f32 v59, v180, v146, v147
  v_fma_f32 v131, -v181, v146, v58
  v_fma_f32 v147, v181, v130, v59
  v_fma_f32 v58, v180, v131, v132
  s_add_u32 m0, s36, 22528
  s_nop 0
  buffer_load_dwordx4 v9, s[88:91], s31 offen offset:3072 lds
  s_waitcnt lgkmcnt(4)
  v_mfma_f32_16x16x32_bf16 v[160:163], v[252:255], v[216:219], v[160:163]
  ds_read_b64_tr_b16 v[176:177], v35 offset:256
  ds_read_b64_tr_b16 v[178:179], v35 offset:384
  ds_read_b64_tr_b16 v[200:201], v30 offset:3584
  ds_read_b64_tr_b16 v[202:203], v31 offset:3584
  v_fma_f32 v59, v180, v147, v148
  v_fma_f32 v132, -v181, v147, v58
  v_fma_f32 v148, v181, v131, v59
  s_add_u32 s31, s31, 4096
  s_cmp_eq_u32 s31, 24576
  s_cselect_b32 s31, 0, s31
  s_add_u32 m0, s36, 32768
  s_nop 0
  buffer_load_dwordx4 v9, s[88:91], s31 offen offset:0 lds
  v_mfma_f32_32x32x16_bf16 v[80:95], v[212:215], a[192:195], v[80:95]
  ds_read_b64_tr_b16 v[204:205], v30 offset:4096
  ds_read_b64_tr_b16 v[206:207], v31 offset:4096
  v_fma_f32 v58, v180, v132, v133
  v_fma_f32 v59, v180, v148, v149
  v_fma_f32 v133, -v181, v148, v58
  v_fma_f32 v149, v181, v132, v59
  v_cvt_pk_bf16_f32 v236, v128, v129
  v_cvt_pk_bf16_f32 v244, -v144, -v145
  s_add_u32 m0, s36, 32768
  s_nop 0
  buffer_load_dwordx4 v9, s[88:91], s31 offen offset:1024 lds
  v_fma_f32 v58, v180, v133, v134
  v_fma_f32 v59, v180, v149, v150
  v_fma_f32 v134, -v181, v149, v58
  v_fma_f32 v150, v181, v133, v59
  v_fma_f32 v58, v180, v134, v135
  s_waitcnt lgkmcnt(8)
  v_mfma_f32_32x32x16_bf16 v[96:111], v[192:195], a[192:195], v[96:111]
  v_fma_f32 v59, v180, v150, v151
  v_cvt_pk_bf16_f32 v237, v130, v131
  s_add_u32 m0, s36, 38912
  s_nop 0
  buffer_load_dwordx4 v9, s[88:91], s31 offen offset:2048 lds
  v_cvt_pk_bf16_f32 v245, -v146, -v147
  v_fma_f32 v135, -v181, v150, v58
  v_fma_f32 v151, v181, v134, v59
  v_fma_f32 v58, v180, v135, v136
  v_fma_f32 v59, v180, v151, v152
  v_fma_f32 v136, -v181, v151, v58
  v_fma_f32 v152, v181, v135, v59
  v_cvt_pk_bf16_f32 v238, v132, v133
  v_cvt_pk_bf16_f32 v246, -v148, -v149
  v_fma_f32 v58, v180, v136, v137
  s_add_u32 m0, s36, 38912
  s_nop 0
  buffer_load_dwordx4 v9, s[88:91], s31 offen offset:3072 lds
  s_waitcnt lgkmcnt(4)
  v_mfma_f32_16x16x32_bf16 v[164:167], v[176:179], v[216:219], 0
  ds_read_b64_tr_b16 v[252:253], v35 offset:28928
  ds_read_b64_tr_b16 v[254:255], v35 offset:29056
  ds_read_b64_tr_b16 v[208:209], v30 offset:4608
  ds_read_b64_tr_b16 v[210:211], v31 offset:4608
  v_fma_f32 v59, v180, v152, v153
  v_fma_f32 v137, -v181, v152, v58
  v_fma_f32 v153, v181, v136, v59
  buffer_load_dwordx4 a[0:3], v21, s[88:91], s14 offen offset:0
  v_fma_f32 v58, v180, v137, v138
  v_fma_f32 v59, v180, v153, v154
  v_mfma_f32_32x32x16_bf16 v[112:127], v[196:199], a[192:195], v[112:127]
  ds_read_b64_tr_b16 v[212:213], v30 offset:5120
  ds_read_b64_tr_b16 v[214:215], v31 offset:5120
  v_cvt_pk_bf16_f32 v239, v134, v135
  v_cvt_pk_bf16_f32 v247, -v150, -v151
  v_fma_f32 v138, -v181, v153, v58
  v_fma_f32 v154, v181, v137, v59
  buffer_load_dwordx4 a[4:7], v22, s[88:91], s14 offen offset:0
  v_fma_f32 v58, v180, v138, v139
  v_fma_f32 v59, v180, v154, v155
  v_fma_f32 v139, -v181, v154, v58
  v_fma_f32 v155, v181, v138, v59
  v_cvt_pk_bf16_f32 v240, v136, v137
  v_cvt_pk_bf16_f32 v248, -v152, -v153
  v_fma_f32 v58, v180, v139, v140
  s_waitcnt lgkmcnt(8)
  v_mfma_f32_32x32x16_bf16 v[64:79], v[200:203], a[196:199], v[64:79]
  buffer_load_dwordx4 a[8:11], v21, s[88:91], s14 offen offset:2048
  v_fma_f32 v59, v180, v155, v156
  v_fma_f32 v140, -v181, v155, v58
  v_fma_f32 v156, v181, v139, v59
  v_fma_f32 v58, v180, v140, v141
  v_fma_f32 v59, v180, v156, v157
  v_cvt_pk_bf16_f32 v241, v138, v139
  v_cvt_pk_bf16_f32 v249, -v154, -v155
  v_fma_f32 v141, -v181, v156, v58
  v_fma_f32 v157, v181, v140, v59
  v_fma_f32 v58, v180, v141, v142
  buffer_load_dwordx4 a[12:15], v22, s[88:91], s14 offen offset:2048
  v_fma_f32 v59, v180, v157, v158
  v_fma_f32 v142, -v181, v157, v58
  s_waitcnt lgkmcnt(4)
  v_mfma_f32_16x16x32_bf16 v[164:167], v[252:255], v[216:219], v[164:167]
  ds_read_b64_tr_b16 v[176:177], v35 offset:512
  ds_read_b64_tr_b16 v[178:179], v35 offset:640
  ds_read_b64_tr_b16 v[192:193], v30 offset:7168
  ds_read_b64_tr_b16 v[194:195], v31 offset:7168
  v_accvgpr_read_b32 v44, a200
  s_add_u32 s14, s14, 4096
  s_and_b32 s14, s14, 32767
  buffer_load_dwordx4 a[16:19], v21, s[88:91], s14 offen offset:0
  v_fma_f32 v158, v181, v141, v59
  v_cvt_pk_bf16_f32 v242, v140, v141
  v_cvt_pk_bf16_f32 v250, -v156, -v157
  v_fma_f32 v58, v180, v142, v143
  v_mfma_f32_32x32x16_bf16 v[80:95], v[204:207], a[196:199], v[80:95]
  ds_read_b64_tr_b16 v[196:197], v30 offset:7680
  ds_read_b64_tr_b16 v[198:199], v31 offset:7680
  v_accvgpr_read_b32 v45, a204
  v_fma_f32 v59, v180, v158, v159
  buffer_load_dwordx4 a[20:23], v22, s[88:91], s14 offen offset:0
  v_fma_f32 v143, -v181, v158, v58
  v_fma_f32 v159, v181, v142, v59
  v_cvt_pk_bf16_f32 v243, v142, v143
  v_cvt_pk_bf16_f32 v251, -v158, -v159
  v_mul_u32_u24 v2, 80, v6
  v_lshl_add_u32 v2, v7, 5, v2
  v_add_u32 v2, s49, v2
  ds_write_b128 v2, v[236:239] offset:7168
  buffer_load_dwordx4 a[24:27], v21, s[88:91], s14 offen offset:2048
  s_waitcnt lgkmcnt(9)
  v_mfma_f32_32x32x16_bf16 v[96:111], v[208:211], a[196:199], v[96:111]
  ds_write_b128 v2, v[240:243] offset:7184
  ds_write_b128 v2, v[244:247] offset:9728
  buffer_load_dwordx4 a[28:31], v22, s[88:91], s14 offen offset:2048
  ds_write_b128 v2, v[248:251] offset:9744
  s_waitcnt lgkmcnt(8)
  v_mfma_f32_16x16x32_bf16 v[168:171], v[176:179], v[216:219], 0
  ds_read_b64_tr_b16 v[252:253], v35 offset:29184
  ds_read_b64_tr_b16 v[254:255], v35 offset:29312
  s_add_u32 s14, s14, 4096
  s_and_b32 s14, s14, 32767
  buffer_load_dwordx4 a[32:35], v21, s[88:91], s14 offen offset:0
  ds_read_b64_tr_b16 v[200:201], v30 offset:8192
  ds_read_b64_tr_b16 v[202:203], v31 offset:8192
  v_cmp_u_f32 vcc, v44, v45
  s_cbranch_vccnz L_ck_53
L_ckr_54:
  v_bfe_u32 v3, v1, 2, 2
  v_lshl_add_u32 v3, v7, 3, v3
  v_mul_u32_u24 v3, 80, v3
  v_mfma_f32_32x32x16_bf16 v[112:127], v[212:215], a[196:199], v[112:127]
  ds_read_b64_tr_b16 v[204:205], v30 offset:8704
  buffer_load_dwordx4 a[36:39], v22, s[88:91], s14 offen offset:0
  ds_read_b64_tr_b16 v[206:207], v31 offset:8704
  v_and_b32 v2, 1, v1
  v_lshl_add_u32 v3, v2, 5, v3
  v_bfe_u32 v2, v1, 4, 1
  v_lshl_add_u32 v3, v2, 4, v3
  v_bfe_u32 v2, v1, 1, 1
  v_lshl_add_u32 v3, v2, 3, v3
  v_add_u32 v3, s49, v3
  ds_read_b64_tr_b16 v[220:221], v3 offset:7168
  buffer_load_dwordx4 a[40:43], v21, s[88:91], s14 offen offset:2048
  ds_read_b64_tr_b16 v[222:223], v3 offset:7488
  ds_read_b64_tr_b16 v[224:225], v3 offset:8448
  s_waitcnt lgkmcnt(15)
  v_mfma_f32_32x32x16_bf16 v[64:79], v[192:195], a[200:203], v[64:79]
  ds_read_b64_tr_b16 v[226:227], v3 offset:8768
  ds_read_b64_tr_b16 v[228:229], v3 offset:9728
  ds_read_b64_tr_b16 v[230:231], v3 offset:10048
  ds_read_b64_tr_b16 v[232:233], v3 offset:11008
  ds_read_b64_tr_b16 v[234:235], v3 offset:11328
  buffer_load_dwordx4 a[44:47], v22, s[88:91], s14 offen offset:2048
  v_lshlrev_b32 v5, 5, v7
  v_add_u32 v5, 160768, v5
  s_waitcnt lgkmcnt(6)
  buffer_store_dwordx4 v[220:223], v8, s[88:91], s39 offen offset:0 sc0 sc1
  s_waitcnt lgkmcnt(4)
  buffer_store_dwordx4 v[224:227], v8, s[88:91], s39 offen offset:1024 sc0 sc1
  s_waitcnt lgkmcnt(2)
  buffer_store_dwordx4 v[228:231], v8, s[88:91], s39 offen offset:2048 sc0 sc1
  s_waitcnt lgkmcnt(0)
  buffer_store_dwordx4 v[232:235], v8, s[88:91], s39 offen offset:3072 sc0 sc1
  v_mfma_f32_16x16x32_bf16 v[168:171], v[252:255], v[216:219], v[168:171]
  ds_read_b64_tr_b16 v[176:177], v35 offset:768
  ds_read_b64_tr_b16 v[178:179], v35 offset:896
  ds_read_b64_tr_b16 v[208:209], v30 offset:10752
  ds_read_b64_tr_b16 v[210:211], v31 offset:10752
  v_mfma_f32_32x32x16_bf16 v[80:95], v[196:199], a[200:203], v[80:95]
  s_waitcnt lgkmcnt(2)
  v_mfma_f32_16x16x32_bf16 v[172:175], v[176:179], v[216:219], 0
  ds_read_b64_tr_b16 v[252:253], v35 offset:29440
  s_add_u32 s14, s14, 4096
  s_and_b32 s14, s14, 32767
  buffer_load_dwordx4 a[48:51], v21, s[88:91], s14 offen offset:0
  ds_read_b64_tr_b16 v[254:255], v35 offset:29568
  ds_read_b64_tr_b16 v[212:213], v30 offset:11264
  ds_read_b64_tr_b16 v[214:215], v31 offset:11264
  v_mfma_f32_32x32x16_bf16 v[96:111], v[200:203], a[200:203], v[96:111]
  ds_read_b64_tr_b16 v[192:193], v30 offset:11776
  ds_read_b64_tr_b16 v[194:195], v31 offset:11776
  v_mfma_f32_32x32x16_bf16 v[112:127], v[204:207], a[200:203], v[112:127]
  buffer_load_dwordx4 a[52:55], v22, s[88:91], s14 offen offset:0
  s_waitcnt lgkmcnt(4)
  v_mfma_f32_16x16x32_bf16 v[172:175], v[252:255], v[216:219], v[172:175]
  ds_read_b64_tr_b16 v[196:197], v30 offset:12288
  ds_read_b64_tr_b16 v[198:199], v31 offset:12288
  v_mfma_f32_32x32x16_bf16 v[64:79], v[208:211], a[204:207], v[64:79]
  ds_read_b64_tr_b16 v[200:201], v30 offset:14336
  buffer_load_dwordx4 a[56:59], v21, s[88:91], s14 offen offset:2048
  ds_read_b64_tr_b16 v[202:203], v31 offset:14336
  s_waitcnt vmcnt(42)
  v_accvgpr_read_b32 v44, a208
  s_waitcnt lgkmcnt(6)
  v_mfma_f32_32x32x16_bf16 v[80:95], v[212:215], a[204:207], v[80:95]
  ds_read_b64_tr_b16 v[204:205], v30 offset:14848
  ds_read_b64_tr_b16 v[206:207], v31 offset:14848
  s_waitcnt vmcnt(41)
  v_accvgpr_read_b32 v45, a212
  buffer_load_dwordx4 a[60:63], v22, s[88:91], s14 offen offset:2048
  s_waitcnt lgkmcnt(6)
  v_mfma_f32_32x32x16_bf16 v[96:111], v[192:195], a[204:207], v[96:111]
  ds_read_b64_tr_b16 v[208:209], v30 offset:15360
  ds_read_b64_tr_b16 v[210:211], v31 offset:15360
  v_cmp_u_f32 vcc, v44, v45
  s_cbranch_vccnz L_ck_55
L_ckr_56:
  s_waitcnt lgkmcnt(6)
  v_mfma_f32_32x32x16_bf16 v[112:127], v[196:199], a[204:207], v[112:127]
  s_mov_b32 exec_lo, 0x00010001
  s_mov_b32 exec_hi, 0x00010001
  ds_write_b128 v46, v[160:163] offset:0
  ds_write_b128 v46, v[164:167] offset:64
  ds_write_b128 v46, v[168:171] offset:128
  ds_write_b128 v46, v[172:175] offset:192
  s_mov_b64 exec, -1
  s_add_u32 s14, s14, 4096
  s_and_b32 s14, s14, 32767
  buffer_load_dwordx4 a[64:67], v21, s[88:91], s14 offen offset:0
  ds_read_b64_tr_b16 v[212:213], v30 offset:15872
  ds_read_b64_tr_b16 v[214:215], v31 offset:15872
  s_waitcnt lgkmcnt(10)
  v_mfma_f32_32x32x16_bf16 v[64:79], v[200:203], a[208:211], v[64:79]
  ds_read_b64_tr_b16 v[192:193], v30 offset:17920
  ds_read_b64_tr_b16 v[194:195], v31 offset:17920
  s_waitcnt lgkmcnt(10)
  v_mfma_f32_32x32x16_bf16 v[80:95], v[204:207], a[208:211], v[80:95]
  ds_read_b64_tr_b16 v[176:177], v35 offset:1024
  buffer_load_dwordx4 a[68:71], v22, s[88:91], s14 offen offset:0
  ds_read_b64_tr_b16 v[178:179], v35 offset:1152
  ds_read_b64_tr_b16 v[196:197], v30 offset:18432
  ds_read_b64_tr_b16 v[198:199], v31 offset:18432
  s_waitcnt lgkmcnt(12)
  v_mfma_f32_32x32x16_bf16 v[96:111], v[208:211], a[208:211], v[96:111]
  ds_read_b64_tr_b16 v[200:201], v30 offset:18944
  ds_read_b64_tr_b16 v[202:203], v31 offset:18944
  s_waitcnt lgkmcnt(8)
  v_mfma_f32_32x32x16_bf16 v[112:127], v[212:215], a[208:211], v[112:127]
  buffer_load_dwordx4 a[72:75], v21, s[88:91], s14 offen offset:2048
  s_waitcnt lgkmcnt(4)
  v_mfma_f32_16x16x32_bf16 v[160:163], v[176:179], v[216:219], 0
  ds_read_b64_tr_b16 v[252:253], v35 offset:29696
  ds_read_b64_tr_b16 v[254:255], v35 offset:29824
  ds_read_b64_tr_b16 v[204:205], v30 offset:19456
  buffer_load_dwordx4 a[76:79], v22, s[88:91], s14 offen offset:2048
  ds_read_b64_tr_b16 v[206:207], v31 offset:19456
  v_mfma_f32_32x32x16_bf16 v[64:79], v[192:195], a[212:215], v[64:79]
  s_waitcnt lgkmcnt(2)
  v_mfma_f32_16x16x32_bf16 v[160:163], v[252:255], v[216:219], v[160:163]
  ds_read_b64_tr_b16 v[176:177], v35 offset:1280
  s_add_u32 s14, s14, 4096
  s_and_b32 s14, s14, 32767
  buffer_load_dwordx4 a[80:83], v21, s[88:91], s14 offen offset:0
  ds_read_b64_tr_b16 v[178:179], v35 offset:1408
  ds_read_b64_tr_b16 v[208:209], v30 offset:21504
  ds_read_b64_tr_b16 v[210:211], v31 offset:21504
  s_waitcnt vmcnt(46)
  v_accvgpr_read_b32 v44, a216
  v_mfma_f32_32x32x16_bf16 v[80:95], v[196:199], a[212:215], v[80:95]
  ds_read_b64_tr_b16 v[212:213], v30 offset:22016
  ds_read_b64_tr_b16 v[214:215], v31 offset:22016
  s_waitcnt vmcnt(45)
  v_accvgpr_read_b32 v45, a220
  buffer_load_dwordx4 a[84:87], v22, s[88:91], s14 offen offset:0
  v_mfma_f32_32x32x16_bf16 v[96:111], v[200:203], a[212:215], v[96:111]
  s_waitcnt lgkmcnt(4)
  v_mfma_f32_16x16x32_bf16 v[164:167], v[176:179], v[216:219], 0
  ds_read_b64_tr_b16 v[252:253], v35 offset:29952
  buffer_load_dwordx4 a[88:91], v21, s[88:91], s14 offen offset:2048
  ds_read_b64_tr_b16 v[254:255], v35 offset:30080
  ds_read_b64_tr_b16 v[192:193], v30 offset:22528
  ds_read_b64_tr_b16 v[194:195], v31 offset:22528
  v_cmp_u_f32 vcc, v44, v45
  s_cbranch_vccnz L_ck_57
L_ckr_58:
  v_mfma_f32_32x32x16_bf16 v[112:127], v[204:207], a[212:215], v[112:127]
  ds_read_b64_tr_b16 v[196:197], v30 offset:23040
  ds_read_b64_tr_b16 v[198:199], v31 offset:23040
  s_waitcnt lgkmcnt(8)
  v_mfma_f32_32x32x16_bf16 v[64:79], v[208:211], a[216:219], v[64:79]
  buffer_load_dwordx4 a[92:95], v22, s[88:91], s14 offen offset:2048
  s_waitcnt vmcnt(12)
  s_mov_b64 exec, 1
  s_cmp_lg_u32 s18, 0
  s_cbranch_scc1 L_slow_59
  buffer_store_dword v11, v12, s[88:91], s25 offen offset:768
L_sret_60:
  s_mov_b64 exec, -1
  s_waitcnt lgkmcnt(4)
  v_mfma_f32_16x16x32_bf16 v[164:167], v[252:255], v[216:219], v[164:167]
  ds_read_b64_tr_b16 v[176:177], v35 offset:1536
  ds_read_b64_tr_b16 v[178:179], v35 offset:1664
  ds_read_b64_tr_b16 v[200:201], v30 offset:25088
  ds_read_b64_tr_b16 v[202:203], v31 offset:25088
  v_mfma_f32_32x32x16_bf16 v[80:95], v[212:215], a[216:219], v[80:95]
  ds_read_b64_tr_b16 v[204:205], v30 offset:25600
  s_add_u32 s14, s14, 4096
  s_and_b32 s14, s14, 32767
  buffer_load_dwordx4 a[96:99], v21, s[88:91], s14 offen offset:0
  ds_read_b64_tr_b16 v[206:207], v31 offset:25600
  s_waitcnt lgkmcnt(8)
  v_mfma_f32_32x32x16_bf16 v[96:111], v[192:195], a[216:219], v[96:111]
  s_waitcnt lgkmcnt(4)
  v_mfma_f32_16x16x32_bf16 v[168:171], v[176:179], v[216:219], 0
  ds_read_b64_tr_b16 v[252:253], v35 offset:30208
  buffer_load_dwordx4 a[100:103], v22, s[88:91], s14 offen offset:0
  ds_read_b64_tr_b16 v[254:255], v35 offset:30336
  ds_read_b64_tr_b16 v[208:209], v30 offset:26112
  ds_read_b64_tr_b16 v[210:211], v31 offset:26112
  v_mfma_f32_32x32x16_bf16 v[112:127], v[196:199], a[216:219], v[112:127]
  ds_read_b64_tr_b16 v[212:213], v30 offset:26624
  ds_read_b64_tr_b16 v[214:215], v31 offset:26624
  s_waitcnt lgkmcnt(8)
  v_mfma_f32_32x32x16_bf16 v[64:79], v[200:203], a[220:223], v[64:79]
  buffer_load_dwordx4 a[104:107], v21, s[88:91], s14 offen offset:2048
  s_waitcnt lgkmcnt(4)
  v_mfma_f32_16x16x32_bf16 v[168:171], v[252:255], v[216:219], v[168:171]
  ds_read_b64_tr_b16 v[192:193], v30 offset:28672
  ds_read_b64_tr_b16 v[194:195], v31 offset:28672
  v_accvgpr_read_b32 v44, a224
  buffer_load_dwordx4 a[108:111], v22, s[88:91], s14 offen offset:2048
  v_mfma_f32_32x32x16_bf16 v[80:95], v[204:207], a[220:223], v[80:95]
  ds_read_b64_tr_b16 v[196:197], v30 offset:29184
  ds_read_b64_tr_b16 v[198:199], v31 offset:29184
  v_accvgpr_read_b32 v45, a228
  s_waitcnt lgkmcnt(6)
  v_mfma_f32_32x32x16_bf16 v[96:111], v[208:211], a[220:223], v[96:111]
  ds_read_b64_tr_b16 v[200:201], v30 offset:29696
  s_add_u32 s14, s14, 4096
  s_and_b32 s14, s14, 32767
  buffer_load_dwordx4 a[112:115], v21, s[88:91], s14 offen offset:0
  ds_read_b64_tr_b16 v[202:203], v31 offset:29696
  v_cmp_u_f32 vcc, v44, v45
  s_cbranch_vccnz L_ck_61
L_ckr_62:
  s_waitcnt lgkmcnt(6)
  v_mfma_f32_32x32x16_bf16 v[112:127], v[212:215], a[220:223], v[112:127]
  ds_read_b64_tr_b16 v[204:205], v30 offset:30208
  ds_read_b64_tr_b16 v[206:207], v31 offset:30208
  s_waitcnt lgkmcnt(6)
  v_mfma_f32_32x32x16_bf16 v[64:79], v[192:195], a[224:227], v[64:79]
  s_mov_b32 exec_lo, 0x00010001
  s_mov_b32 exec_hi, 0x00010001
  ds_write_b128 v46, v[160:163] offset:256
  ds_write_b128 v46, v[164:167] offset:320
  ds_write_b128 v46, v[168:171] offset:384
  s_mov_b64 exec, -1
  buffer_load_dwordx4 a[116:119], v22, s[88:91], s14 offen offset:0
  ds_read_b64_tr_b16 v[208:209], v30 offset:32256
  ds_read_b64_tr_b16 v[210:211], v31 offset:32256
  s_waitcnt lgkmcnt(9)
  v_mfma_f32_32x32x16_bf16 v[80:95], v[196:199], a[224:227], v[80:95]
  s_waitcnt lgkmcnt(0)
  s_barrier
  ds_read_b64_tr_b16 v[212:213], v30 offset:32768
  ds_read_b64_tr_b16 v[214:215], v31 offset:32768
  v_lshlrev_b32 v32, 3, v1
  s_add_u32 s31, s31, 4096
  s_cmp_eq_u32 s31, 24576
  s_cselect_b32 s31, 0, s31
  s_add_u32 m0, s36, 49152
  s_nop 0
  buffer_load_dwordx4 v9, s[88:91], s31 offen offset:0 lds
  v_mfma_f32_32x32x16_bf16 v[96:111], v[200:203], a[224:227], v[96:111]
  ds_read_b64_tr_b16 v[192:193], v30 offset:33280
  ds_read_b64_tr_b16 v[194:195], v31 offset:33280
  v_add_u32 v35, 156672, v32
  ds_read_b64 v[160:161], v35 offset:0
  ds_read_b64 v[162:163], v35 offset:512
  ds_read_b64 v[164:165], v35 offset:1024
  s_add_u32 m0, s36, 49152
  s_nop 0
  buffer_load_dwordx4 v9, s[88:91], s31 offen offset:1024 lds
  v_mfma_f32_32x32x16_bf16 v[112:127], v[204:207], a[224:227], v[112:127]
  ds_read_b64_tr_b16 v[196:197], v30 offset:33792
  ds_read_b64_tr_b16 v[198:199], v31 offset:33792
  ds_read_b64 v[166:167], v35 offset:1536
  ds_read_b64 v[168:169], v35 offset:2048
  ds_read_b64 v[170:171], v35 offset:2560
  ds_read_b64 v[172:173], v35 offset:3072
  ds_read_b64 v[174:175], v35 offset:3584
  v_add_u32 v35, 160768, v32
  s_add_u32 m0, s36, 55296
  s_nop 0
  buffer_load_dwordx4 v9, s[88:91], s31 offen offset:2048 lds
  v_mfma_f32_32x32x16_bf16 v[64:79], v[208:211], a[228:231], v[64:79]
  ds_read_b64_tr_b16 v[200:201], v30 offset:35840
  ds_read_b64_tr_b16 v[202:203], v31 offset:35840
  v_accvgpr_read_b32 v44, a232
  s_waitcnt lgkmcnt(10)
  v_add_f32 v160, v160, v162
  v_add_f32 v161, v161, v163
  s_waitcnt lgkmcnt(6)
  v_add_f32 v164, v164, v166
  s_add_u32 m0, s36, 55296
  s_nop 0
  buffer_load_dwordx4 v9, s[88:91], s31 offen offset:3072 lds
  v_mfma_f32_32x32x16_bf16 v[80:95], v[212:215], a[228:231], v[80:95]
  ds_read_b64_tr_b16 v[204:205], v30 offset:36352
  ds_read_b64_tr_b16 v[206:207], v31 offset:36352
  v_accvgpr_read_b32 v45, a236
  v_add_f32 v165, v165, v167
  s_waitcnt lgkmcnt(6)
  v_add_f32 v168, v168, v170
  v_add_f32 v169, v169, v171
  s_waitcnt lgkmcnt(4)
  v_add_f32 v172, v172, v174
  s_add_u32 s31, s31, 4096
  s_cmp_eq_u32 s31, 24576
  s_cselect_b32 s31, 0, s31
  s_add_u32 m0, s36, 65536
  s_nop 0
  buffer_load_dwordx4 v9, s[88:91], s31 offen offset:0 lds
  v_mfma_f32_32x32x16_bf16 v[96:111], v[192:195], a[228:231], v[96:111]
  ds_read_b64_tr_b16 v[208:209], v30 offset:36864
  ds_read_b64_tr_b16 v[210:211], v31 offset:36864
  v_cmp_u_f32 vcc, v44, v45
  s_cbranch_vccnz L_ck_63
L_ckr_64:
  v_add_f32 v173, v173, v175
  v_add_f32 v160, v160, v164
  v_add_f32 v161, v161, v165
  v_add_f32 v168, v168, v172
  s_add_u32 m0, s36, 65536
  s_nop 0
  buffer_load_dwordx4 v9, s[88:91], s31 offen offset:1024 lds
  v_mfma_f32_32x32x16_bf16 v[112:127], v[196:199], a[228:231], v[112:127]
  ds_read_b64_tr_b16 v[212:213], v30 offset:37376
  ds_read_b64_tr_b16 v[214:215], v31 offset:37376
  v_add_f32 v169, v169, v173
  v_add_f32 v160, v160, v168
  v_add_f32 v161, v161, v169
  ds_write_b64 v35, v[160:161]
  s_add_u32 m0, s36, 71680
  s_nop 0
  buffer_load_dwordx4 v9, s[88:91], s31 offen offset:2048 lds
  s_waitcnt lgkmcnt(7)
  v_mfma_f32_32x32x16_bf16 v[64:79], v[200:203], a[232:235], v[64:79]
  ds_read_b64_tr_b16 v[192:193], v30 offset:39424
  ds_read_b64_tr_b16 v[194:195], v31 offset:39424
  buffer_load_dword v23, v13, s[88:91], s24 offen offset:768 sc1
  s_waitcnt lgkmcnt(7)
  v_mfma_f32_32x32x16_bf16 v[80:95], v[204:207], a[232:235], v[80:95]
  ds_read_b64_tr_b16 v[196:197], v30 offset:39936
  ds_read_b64_tr_b16 v[198:199], v31 offset:39936
  s_waitcnt lgkmcnt(7)
  v_mfma_f32_32x32x16_bf16 v[96:111], v[208:211], a[232:235], v[96:111]
  ds_read_b64_tr_b16 v[200:201], v30 offset:40448
  s_add_u32 m0, s36, 71680
  s_nop 0
  buffer_load_dwordx4 v9, s[88:91], s31 offen offset:3072 lds
  ds_read_b64_tr_b16 v[202:203], v31 offset:40448
  s_waitcnt lgkmcnt(7)
  v_mfma_f32_32x32x16_bf16 v[112:127], v[212:215], a[232:235], v[112:127]
  ds_read_b64_tr_b16 v[204:205], v30 offset:40960
  ds_read_b64_tr_b16 v[206:207], v31 offset:40960
  s_waitcnt lgkmcnt(6)
  v_mfma_f32_32x32x16_bf16 v[64:79], v[192:195], a[236:239], v[64:79]
  ds_read_b64_tr_b16 v[208:209], v30 offset:43008
  s_add_u32 s31, s31, 4096
  s_cmp_eq_u32 s31, 24576
  s_cselect_b32 s31, 0, s31
  s_add_u32 m0, s36, 81920
  s_nop 0
  buffer_load_dwordx4 v9, s[88:91], s31 offen offset:0 lds
  ds_read_b64_tr_b16 v[210:211], v31 offset:43008
  v_accvgpr_read_b32 v44, a240
  s_waitcnt lgkmcnt(6)
  v_mfma_f32_32x32x16_bf16 v[80:95], v[196:199], a[236:239], v[80:95]
  ds_read_b64_tr_b16 v[212:213], v30 offset:43520
  ds_read_b64_tr_b16 v[214:215], v31 offset:43520
  v_accvgpr_read_b32 v45, a244
  s_waitcnt lgkmcnt(6)
  v_mfma_f32_32x32x16_bf16 v[96:111], v[200:203], a[236:239], v[96:111]
  ds_read_b64_tr_b16 v[192:193], v30 offset:44032
  s_add_u32 m0, s36, 81920
  s_nop 0
  buffer_load_dwordx4 v9, s[88:91], s31 offen offset:1024 lds
  ds_read_b64_tr_b16 v[194:195], v31 offset:44032
  v_cmp_u_f32 vcc, v44, v45
  s_cbranch_vccnz L_ck_65
L_ckr_66:
  s_waitcnt lgkmcnt(6)
  v_mfma_f32_32x32x16_bf16 v[112:127], v[204:207], a[236:239], v[112:127]
  ds_read_b64_tr_b16 v[196:197], v30 offset:44544
  ds_read_b64_tr_b16 v[198:199], v31 offset:44544
  s_waitcnt lgkmcnt(6)
  v_mfma_f32_32x32x16_bf16 v[64:79], v[208:211], a[240:243], v[64:79]
  ds_read_b64_tr_b16 v[200:201], v30 offset:46592
  s_add_u32 m0, s36, 88064
  s_nop 0
  buffer_load_dwordx4 v9, s[88:91], s31 offen offset:2048 lds
  ds_read_b64_tr_b16 v[202:203], v31 offset:46592
  s_waitcnt lgkmcnt(6)
  v_mfma_f32_32x32x16_bf16 v[80:95], v[212:215], a[240:243], v[80:95]
  ds_read_b64_tr_b16 v[204:205], v30 offset:47104
  ds_read_b64_tr_b16 v[206:207], v31 offset:47104
L_stub5:
  s_cbranch_execz L_stubret
  s_waitcnt lgkmcnt(6)
  v_mfma_f32_32x32x16_bf16 v[96:111], v[192:195], a[240:243], v[96:111]
  ds_read_b64_tr_b16 v[208:209], v30 offset:47616
  s_add_u32 m0, s36, 88064
  s_nop 0
  buffer_load_dwordx4 v9, s[88:91], s31 offen offset:3072 lds
  ds_read_b64_tr_b16 v[210:211], v31 offset:47616
  s_waitcnt lgkmcnt(6)
  v_mfma_f32_32x32x16_bf16 v[112:127], v[196:199], a[240:243], v[112:127]
  ds_read_b64_tr_b16 v[212:213], v30 offset:48128
  ds_read_b64_tr_b16 v[214:215], v31 offset:48128
  s_waitcnt lgkmcnt(6)
  v_mfma_f32_32x32x16_bf16 v[64:79], v[200:203], a[244:247], v[64:79]
  ds_read_b64_tr_b16 v[192:193], v30 offset:50176
  buffer_load_dwordx4 a[120:123], v21, s[88:91], s14 offen offset:2048
  ds_read_b64_tr_b16 v[194:195], v31 offset:50176
  v_accvgpr_read_b32 v44, a248
  s_waitcnt lgkmcnt(6)
  v_mfma_f32_32x32x16_bf16 v[80:95], v[204:207], a[244:247], v[80:95]
  ds_read_b64_tr_b16 v[196:197], v30 offset:50688
  ds_read_b64_tr_b16 v[198:199], v31 offset:50688
  v_accvgpr_read_b32 v45, a252
  s_waitcnt lgkmcnt(6)
  v_mfma_f32_32x32x16_bf16 v[96:111], v[208:211], a[244:247], v[96:111]
  ds_read_b64_tr_b16 v[200:201], v30 offset:51200
  buffer_load_dwordx4 a[124:127], v22, s[88:91], s14 offen offset:2048
  ds_read_b64_tr_b16 v[202:203], v31 offset:51200
  v_cmp_u_f32 vcc, v44, v45
  s_cbranch_vccnz L_ck_67
L_ckr_68:
  s_waitcnt lgkmcnt(6)
  v_mfma_f32_32x32x16_bf16 v[112:127], v[212:215], a[244:247], v[112:127]
  ds_read_b64_tr_b16 v[204:205], v30 offset:51712
  ds_read_b64_tr_b16 v[206:207], v31 offset:51712
  s_waitcnt lgkmcnt(6)
  v_mfma_f32_32x32x16_bf16 v[64:79], v[192:195], a[248:251], v[64:79]
  ds_read_b64_tr_b16 v[208:209], v30 offset:53760
  ds_read_b64_tr_b16 v[210:211], v31 offset:53760
  s_waitcnt lgkmcnt(6)
  v_mfma_f32_32x32x16_bf16 v[80:95], v[196:199], a[248:251], v[80:95]
  ds_read_b64_tr_b16 v[212:213], v30 offset:54272
  ds_read_b64_tr_b16 v[214:215], v31 offset:54272
  s_waitcnt lgkmcnt(6)
  v_mfma_f32_32x32x16_bf16 v[96:111], v[200:203], a[248:251], v[96:111]
  ds_read_b64_tr_b16 v[192:193], v30 offset:54784
  ds_read_b64_tr_b16 v[194:195], v31 offset:54784
  s_waitcnt lgkmcnt(6)
  v_mfma_f32_32x32x16_bf16 v[112:127], v[204:207], a[248:251], v[112:127]
  ds_read_b64_tr_b16 v[196:197], v30 offset:55296
  ds_read_b64_tr_b16 v[198:199], v31 offset:55296
  s_waitcnt vmcnt(7)
  v_cmp_ne_u32 vcc, v23, v11
  s_nop 1
  s_and_b64 vcc, vcc, s[40:41]
  s_cbranch_scc1 L_lz_69
L_lzr_70:
  buffer_load_dwordx4 a[128:131], v24, s[88:91], s15 offen offset:0 sc1
  s_waitcnt lgkmcnt(6)
  v_mfma_f32_32x32x16_bf16 v[64:79], v[208:211], a[252:255], v[64:79]
  s_waitcnt lgkmcnt(4)
  v_mfma_f32_32x32x16_bf16 v[80:95], v[212:215], a[252:255], v[80:95]
  buffer_load_dwordx4 a[132:135], v25, s[88:91], s15 offen offset:0 sc1
  s_waitcnt lgkmcnt(2)
  v_mfma_f32_32x32x16_bf16 v[96:111], v[192:195], a[252:255], v[96:111]
  s_waitcnt lgkmcnt(0)
  v_mfma_f32_32x32x16_bf16 v[112:127], v[196:199], a[252:255], v[112:127]
  s_barrier
  ds_read_b128 v[160:163], v5 offset:0
  buffer_load_dwordx4 a[136:139], v24, s[88:91], s15 offen offset:1024 sc1
  ds_read_b128 v[164:167], v5 offset:16
  ds_read_b128 v[168:171], v5 offset:64
  ds_read_b128 v[172:175], v5 offset:80
  ds_read_b128 v[220:223], v5 offset:128
  ds_read_b128 v[224:227], v5 offset:144
  ds_read_b128 v[228:231], v5 offset:192
  ds_read_b128 v[232:235], v5 offset:208
  s_waitcnt lgkmcnt(7)
  v_pk_fma_f32 v[64:65], v[160:161], v[62:63], v[64:65] op_sel_hi:[1,0,1]
  v_pk_fma_f32 v[66:67], v[162:163], v[62:63], v[66:67] op_sel_hi:[1,0,1]
  s_waitcnt lgkmcnt(6)
  v_pk_fma_f32 v[68:69], v[164:165], v[62:63], v[68:69] op_sel_hi:[1,0,1]
  buffer_load_dwordx4 a[140:143], v25, s[88:91], s15 offen offset:1024 sc1
  v_pk_fma_f32 v[70:71], v[166:167], v[62:63], v[70:71] op_sel_hi:[1,0,1]
  s_waitcnt lgkmcnt(5)
  v_pk_fma_f32 v[72:73], v[168:169], v[62:63], v[72:73] op_sel_hi:[1,0,1]
  v_pk_fma_f32 v[74:75], v[170:171], v[62:63], v[74:75] op_sel_hi:[1,0,1]
  s_waitcnt lgkmcnt(4)
  v_pk_fma_f32 v[76:77], v[172:173], v[62:63], v[76:77] op_sel_hi:[1,0,1]
  v_pk_fma_f32 v[78:79], v[174:175], v[62:63], v[78:79] op_sel_hi:[1,0,1]
  v_pk_mul_f32 v[236:237], v[64:65], v[64:65]
  v_pk_mul_f32 v[238:239], v[66:67], v[66:67]
  v_pk_mul_f32 v[240:241], v[68:69], v[68:69]
  v_pk_mul_f32 v[242:243], v[70:71], v[70:71]
  v_pk_mul_f32 v[244:245], v[72:73], v[72:73]
  buffer_load_dwordx4 a[144:147], v24, s[88:91], s15 offen offset:2048 sc1
  v_pk_mul_f32 v[246:247], v[74:75], v[74:75]
  v_pk_mul_f32 v[248:249], v[76:77], v[76:77]
  v_pk_mul_f32 v[250:251], v[78:79], v[78:79]
  v_pk_fma_f32 v[236:237], v[236:237], v[60:61], v[60:61] op_sel:[0,1,0] op_sel_hi:[1,1,0]
  v_pk_fma_f32 v[238:239], v[238:239], v[60:61], v[60:61] op_sel:[0,1,0] op_sel_hi:[1,1,0]
  v_pk_fma_f32 v[240:241], v[240:241], v[60:61], v[60:61] op_sel:[0,1,0] op_sel_hi:[1,1,0]
  v_pk_fma_f32 v[242:243], v[242:243], v[60:61], v[60:61] op_sel:[0,1,0] op_sel_hi:[1,1,0]
  v_pk_fma_f32 v[244:245], v[244:245], v[60:61], v[60:61] op_sel:[0,1,0] op_sel_hi:[1,1,0]
  v_pk_fma_f32 v[246:247], v[246:247], v[60:61], v[60:61] op_sel:[0,1,0] op_sel_hi:[1,1,0]
  v_pk_fma_f32 v[248:249], v[248:249], v[60:61], v[60:61] op_sel:[0,1,0] op_sel_hi:[1,1,0]
  v_pk_fma_f32 v[250:251], v[250:251], v[60:61], v[60:61] op_sel:[0,1,0] op_sel_hi:[1,1,0]
  s_xor_b32 s6, s5, 1
  s_mul_i32 s6, s6, 12288
  s_add_u32 s6, s6, 98304
  v_add_u32 v16, s6, v8
  v_pk_mul_f32 v[236:237], v[236:237], v[64:65]
  buffer_load_dwordx4 a[148:151], v25, s[88:91], s15 offen offset:2048 sc1
  v_pk_mul_f32 v[238:239], v[238:239], v[66:67]
  v_pk_mul_f32 v[240:241], v[240:241], v[68:69]
  v_pk_mul_f32 v[242:243], v[242:243], v[70:71]
  v_pk_mul_f32 v[244:245], v[244:245], v[72:73]
  v_pk_mul_f32 v[246:247], v[246:247], v[74:75]
  v_pk_mul_f32 v[248:249], v[248:249], v[76:77]
  v_pk_mul_f32 v[250:251], v[250:251], v[78:79]
  v_exp_f32 v236, v236
  v_exp_f32 v237, v237
  v_exp_f32 v238, v238
  buffer_load_dwordx4 a[152:155], v24, s[88:91], s15 offen offset:3072 sc1
  v_exp_f32 v239, v239
  v_exp_f32 v240, v240
  v_exp_f32 v241, v241
  v_exp_f32 v242, v242
  v_exp_f32 v243, v243
  v_exp_f32 v244, v244
  buffer_load_dwordx4 a[156:159], v25, s[88:91], s15 offen offset:3072 sc1
  v_exp_f32 v245, v245
  v_exp_f32 v246, v246
  v_exp_f32 v247, v247
  v_exp_f32 v248, v248
  v_exp_f32 v249, v249
  v_exp_f32 v250, v250
  s_add_u32 s15, s15, 4096
  s_and_b32 s15, s15, 16383
  buffer_load_dwordx4 a[160:163], v24, s[88:91], s15 offen offset:0 sc1
  v_exp_f32 v251, v251
  s_xor_b32 s6, s5, 2
  s_mul_i32 s6, s6, 12288
  s_add_u32 s6, s6, 102400
  v_add_u32 v18, s6, v8
  v_pk_fma_f32 v[236:237], v[236:237], v[62:63], v[62:63] op_sel:[0,1,1] op_sel_hi:[1,1,1]
  v_pk_fma_f32 v[238:239], v[238:239], v[62:63], v[62:63] op_sel:[0,1,1] op_sel_hi:[1,1,1]
  v_pk_fma_f32 v[240:241], v[240:241], v[62:63], v[62:63] op_sel:[0,1,1] op_sel_hi:[1,1,1]
  v_pk_fma_f32 v[242:243], v[242:243], v[62:63], v[62:63] op_sel:[0,1,1] op_sel_hi:[1,1,1]
  v_pk_fma_f32 v[244:245], v[244:245], v[62:63], v[62:63] op_sel:[0,1,1] op_sel_hi:[1,1,1]
  v_pk_fma_f32 v[246:247], v[246:247], v[62:63], v[62:63] op_sel:[0,1,1] op_sel_hi:[1,1,1]
  buffer_load_dwordx4 a[164:167], v25, s[88:91], s15 offen offset:0 sc1
  v_pk_fma_f32 v[248:249], v[248:249], v[62:63], v[62:63] op_sel:[0,1,1] op_sel_hi:[1,1,1]
  v_pk_fma_f32 v[250:251], v[250:251], v[62:63], v[62:63] op_sel:[0,1,1] op_sel_hi:[1,1,1]
  v_rcp_f32 v236, v236
  v_rcp_f32 v237, v237
  v_rcp_f32 v238, v238
  v_rcp_f32 v239, v239
  v_rcp_f32 v240, v240
  buffer_load_dwordx4 a[168:171], v24, s[88:91], s15 offen offset:1024 sc1
  v_rcp_f32 v241, v241
  v_rcp_f32 v242, v242
  v_rcp_f32 v243, v243
  v_rcp_f32 v244, v244
  v_rcp_f32 v245, v245
  v_rcp_f32 v246, v246
  buffer_load_dwordx4 a[172:175], v25, s[88:91], s15 offen offset:1024 sc1
  v_rcp_f32 v247, v247
  v_rcp_f32 v248, v248
  v_rcp_f32 v249, v249
  v_rcp_f32 v250, v250
  v_rcp_f32 v251, v251
  s_xor_b32 s6, s5, 3
  s_mul_i32 s6, s6, 12288
  s_add_u32 s6, s6, 106496
  v_add_u32 v19, s6, v8
  v_pk_mul_f32 v[236:237], v[236:237], v[64:65]
  buffer_load_dwordx4 a[176:179], v24, s[88:91], s15 offen offset:2048 sc1
  v_pk_mul_f32 v[238:239], v[238:239], v[66:67]
  v_pk_mul_f32 v[240:241], v[240:241], v[68:69]
  v_pk_mul_f32 v[242:243], v[242:243], v[70:71]
  v_pk_mul_f32 v[244:245], v[244:245], v[72:73]
  v_pk_mul_f32 v[246:247], v[246:247], v[74:75]
  v_pk_mul_f32 v[248:249], v[248:249], v[76:77]
  v_pk_mul_f32 v[250:251], v[250:251], v[78:79]
  v_cvt_pk_bf16_f32 v176, v236, v237
  v_cvt_pk_bf16_f32 v177, v238, v239
  v_cvt_pk_bf16_f32 v178, v240, v241
  v_cvt_pk_bf16_f32 v179, v242, v243
  v_cvt_pk_bf16_f32 v180, v244, v245
  buffer_load_dwordx4 a[180:183], v25, s[88:91], s15 offen offset:2048 sc1
  v_cvt_pk_bf16_f32 v181, v246, v247
  v_cvt_pk_bf16_f32 v182, v248, v249
  v_cvt_pk_bf16_f32 v183, v250, v251
  ds_read_b128 v[160:163], v5 offset:256
  ds_read_b128 v[164:167], v5 offset:272
  ds_read_b128 v[168:171], v5 offset:320
  ds_read_b128 v[172:175], v5 offset:336
  buffer_store_dwordx4 v[176:179], v8, s[88:91], s42 offen offset:0 sc0 sc1
  buffer_store_dwordx4 v[180:183], v8, s[88:91], s42 offen offset:1024 sc0 sc1
  s_waitcnt lgkmcnt(7)
  v_pk_fma_f32 v[80:81], v[220:221], v[62:63], v[80:81] op_sel_hi:[1,0,1]
  v_pk_fma_f32 v[82:83], v[222:223], v[62:63], v[82:83] op_sel_hi:[1,0,1]
  s_waitcnt lgkmcnt(6)
  v_pk_fma_f32 v[84:85], v[224:225], v[62:63], v[84:85] op_sel_hi:[1,0,1]
  v_pk_fma_f32 v[86:87], v[226:227], v[62:63], v[86:87] op_sel_hi:[1,0,1]
  s_waitcnt lgkmcnt(5)
  v_pk_fma_f32 v[88:89], v[228:229], v[62:63], v[88:89] op_sel_hi:[1,0,1]
  v_pk_fma_f32 v[90:91], v[230:231], v[62:63], v[90:91] op_sel_hi:[1,0,1]
  s_waitcnt lgkmcnt(4)
  v_pk_fma_f32 v[92:93], v[232:233], v[62:63], v[92:93] op_sel_hi:[1,0,1]
  v_pk_fma_f32 v[94:95], v[234:235], v[62:63], v[94:95] op_sel_hi:[1,0,1]
  buffer_load_dwordx4 a[184:187], v24, s[88:91], s15 offen offset:3072 sc1
  v_pk_mul_f32 v[236:237], v[80:81], v[80:81]
  v_pk_mul_f32 v[238:239], v[82:83], v[82:83]
  v_pk_mul_f32 v[240:241], v[84:85], v[84:85]
  v_pk_mul_f32 v[242:243], v[86:87], v[86:87]
  v_pk_mul_f32 v[244:245], v[88:89], v[88:89]
  v_pk_mul_f32 v[246:247], v[90:91], v[90:91]
  v_pk_mul_f32 v[248:249], v[92:93], v[92:93]
  v_pk_mul_f32 v[250:251], v[94:95], v[94:95]
  v_pk_fma_f32 v[236:237], v[236:237], v[60:61], v[60:61] op_sel:[0,1,0] op_sel_hi:[1,1,0]
  v_pk_fma_f32 v[238:239], v[238:239], v[60:61], v[60:61] op_sel:[0,1,0] op_sel_hi:[1,1,0]
  v_pk_fma_f32 v[240:241], v[240:241], v[60:61], v[60:61] op_sel:[0,1,0] op_sel_hi:[1,1,0]
  v_pk_fma_f32 v[242:243], v[242:243], v[60:61], v[60:61] op_sel:[0,1,0] op_sel_hi:[1,1,0]
  buffer_load_dwordx4 a[188:191], v25, s[88:91], s15 offen offset:3072 sc1
  v_pk_fma_f32 v[244:245], v[244:245], v[60:61], v[60:61] op_sel:[0,1,0] op_sel_hi:[1,1,0]
  v_pk_fma_f32 v[246:247], v[246:247], v[60:61], v[60:61] op_sel:[0,1,0] op_sel_hi:[1,1,0]
  v_pk_fma_f32 v[248:249], v[248:249], v[60:61], v[60:61] op_sel:[0,1,0] op_sel_hi:[1,1,0]
  v_pk_fma_f32 v[250:251], v[250:251], v[60:61], v[60:61] op_sel:[0,1,0] op_sel_hi:[1,1,0]
  s_mul_i32 s6, s5, 12288
  s_add_u32 s6, s6, 98304
  v_add_u32 v20, s6, v8
  v_pk_mul_f32 v[236:237], v[236:237], v[80:81]
  v_pk_mul_f32 v[238:239], v[238:239], v[82:83]
  v_pk_mul_f32 v[240:241], v[240:241], v[84:85]
  v_pk_mul_f32 v[242:243], v[242:243], v[86:87]
  v_pk_mul_f32 v[244:245], v[244:245], v[88:89]
  s_add_u32 s15, s15, 4096
  s_and_b32 s15, s15, 16383
  buffer_load_dwordx4 a[192:195], v24, s[88:91], s15 offen offset:0 sc1
  v_pk_mul_f32 v[246:247], v[246:247], v[90:91]
  v_pk_mul_f32 v[248:249], v[248:249], v[92:93]
  v_pk_mul_f32 v[250:251], v[250:251], v[94:95]
  v_exp_f32 v236, v236
  v_exp_f32 v237, v237
  v_exp_f32 v238, v238
  v_exp_f32 v239, v239
  v_exp_f32 v240, v240
  buffer_load_dwordx4 a[196:199], v25, s[88:91], s15 offen offset:0 sc1
  v_exp_f32 v241, v241
  v_exp_f32 v242, v242
  v_exp_f32 v243, v243
  v_exp_f32 v244, v244
  v_exp_f32 v245, v245
  v_exp_f32 v246, v246
  buffer_load_dwordx4 a[200:203], v24, s[88:91], s15 offen offset:1024 sc1
  v_exp_f32 v247, v247
  v_exp_f32 v248, v248
  v_exp_f32 v249, v249
  v_exp_f32 v250, v250
  v_exp_f32 v251, v251
  v_pk_fma_f32 v[236:237], v[236:237], v[62:63], v[62:63] op_sel:[0,1,1] op_sel_hi:[1,1,1]
  v_pk_fma_f32 v[238:239], v[238:239], v[62:63], v[62:63] op_sel:[0,1,1] op_sel_hi:[1,1,1]
  buffer_load_dwordx4 a[204:207], v25, s[88:91], s15 offen offset:1024 sc1
  v_pk_fma_f32 v[240:241], v[240:241], v[62:63], v[62:63] op_sel:[0,1,1] op_sel_hi:[1,1,1]
  v_pk_fma_f32 v[242:243], v[242:243], v[62:63], v[62:63] op_sel:[0,1,1] op_sel_hi:[1,1,1]
  v_pk_fma_f32 v[244:245], v[244:245], v[62:63], v[62:63] op_sel:[0,1,1] op_sel_hi:[1,1,1]
  v_pk_fma_f32 v[246:247], v[246:247], v[62:63], v[62:63] op_sel:[0,1,1] op_sel_hi:[1,1,1]
  v_pk_fma_f32 v[248:249], v[248:249], v[62:63], v[62:63] op_sel:[0,1,1] op_sel_hi:[1,1,1]
  v_pk_fma_f32 v[250:251], v[250:251], v[62:63], v[62:63] op_sel:[0,1,1] op_sel_hi:[1,1,1]
  v_rcp_f32 v236, v236
  v_rcp_f32 v237, v237
  v_rcp_f32 v238, v238
  buffer_load_dwordx4 a[208:211], v24, s[88:91], s15 offen offset:2048 sc1
  v_rcp_f32 v239, v239
  v_rcp_f32 v240, v240
  v_rcp_f32 v241, v241
  v_rcp_f32 v242, v242
  v_rcp_f32 v243, v243
  v_rcp_f32 v244, v244
  buffer_load_dwordx4 a[212:215], v25, s[88:91], s15 offen offset:2048 sc1
  v_rcp_f32 v245, v245
  v_rcp_f32 v246, v246
  v_rcp_f32 v247, v247
  v_rcp_f32 v248, v248
  v_rcp_f32 v249, v249
  v_rcp_f32 v250, v250
  buffer_load_dwordx4 a[216:219], v24, s[88:91], s15 offen offset:3072 sc1
  v_rcp_f32 v251, v251
  v_pk_mul_f32 v[236:237], v[236:237], v[80:81]
  v_pk_mul_f32 v[238:239], v[238:239], v[82:83]
  v_pk_mul_f32 v[240:241], v[240:241], v[84:85]
  v_pk_mul_f32 v[242:243], v[242:243], v[86:87]
  v_pk_mul_f32 v[244:245], v[244:245], v[88:89]
  v_pk_mul_f32 v[246:247], v[246:247], v[90:91]
  v_pk_mul_f32 v[248:249], v[248:249], v[92:93]
  v_pk_mul_f32 v[250:251], v[250:251], v[94:95]
  v_cvt_pk_bf16_f32 v176, v236, v237
  v_cvt_pk_bf16_f32 v177, v238, v239
  buffer_load_dwordx4 a[220:223], v25, s[88:91], s15 offen offset:3072 sc1
  v_cvt_pk_bf16_f32 v178, v240, v241
  v_cvt_pk_bf16_f32 v179, v242, v243
  v_cvt_pk_bf16_f32 v180, v244, v245
  v_cvt_pk_bf16_f32 v181, v246, v247
  v_cvt_pk_bf16_f32 v182, v248, v249
  v_cvt_pk_bf16_f32 v183, v250, v251
  ds_read_b128 v[220:223], v5 offset:384
  ds_read_b128 v[224:227], v5 offset:400
  buffer_store_dwordx4 v[176:179], v8, s[88:91], s42 offen offset:2048 sc0 sc1
  buffer_store_dwordx4 v[180:183], v8, s[88:91], s42 offen offset:3072 sc0 sc1
  s_waitcnt vmcnt(27)
  v_mfma_f32_32x32x16_bf16 v[64:79], a[0:3], a[128:131], 0
  s_waitcnt lgkmcnt(5)
  v_fmac_f32 v96, v160, v62
  v_fmac_f32 v97, v161, v62
  v_fmac_f32 v98, v162, v62
  v_fmac_f32 v99, v163, v62
  s_waitcnt lgkmcnt(4)
  v_fmac_f32 v100, v164, v62
  s_add_u32 s15, s15, 4096
  s_and_b32 s15, s15, 16383
  buffer_load_dwordx4 a[224:227], v24, s[88:91], s15 offen offset:0 sc1
  v_mfma_f32_32x32x16_bf16 v[80:95], a[4:7], a[128:131], 0
  v_fmac_f32 v101, v165, v62
  v_fmac_f32 v102, v166, v62
  v_fmac_f32 v103, v167, v62
  s_waitcnt lgkmcnt(3)
  v_fmac_f32 v104, v168, v62
  v_fmac_f32 v105, v169, v62
  s_waitcnt vmcnt(27)
  v_mfma_f32_32x32x16_bf16 v[128:143], a[0:3], a[132:135], 0
  buffer_load_dwordx4 a[228:231], v25, s[88:91], s15 offen offset:0 sc1
  v_fmac_f32 v106, v170, v62
  v_fmac_f32 v107, v171, v62
  s_waitcnt lgkmcnt(2)
  v_fmac_f32 v108, v172, v62
  v_fmac_f32 v109, v173, v62
  v_mfma_f32_32x32x16_bf16 v[144:159], a[4:7], a[132:135], 0
  v_fmac_f32 v110, v174, v62
  v_fmac_f32 v111, v175, v62
  v_mul_f32 v236, v96, v96
  buffer_load_dwordx4 a[232:235], v24, s[88:91], s15 offen offset:1024 sc1
  s_waitcnt vmcnt(28)
  v_mfma_f32_32x32x16_bf16 v[64:79], a[8:11], a[136:139], v[64:79]
  v_mul_f32 v237, v97, v97
  v_mul_f32 v238, v98, v98
  v_mul_f32 v239, v99, v99
  v_mul_f32 v240, v100, v100
  v_mul_f32 v241, v101, v101
  v_mul_f32 v242, v102, v102
  v_mfma_f32_32x32x16_bf16 v[80:95], a[12:15], a[136:139], v[80:95]
  buffer_load_dwordx4 a[236:239], v25, s[88:91], s15 offen offset:1024 sc1
  v_mul_f32 v243, v103, v103
  v_mul_f32 v244, v104, v104
  v_mul_f32 v245, v105, v105
  v_mul_f32 v246, v106, v106
  v_mul_f32 v247, v107, v107
  s_waitcnt vmcnt(28)
  v_mfma_f32_32x32x16_bf16 v[128:143], a[8:11], a[140:143], v[128:143]
  v_mul_f32 v248, v108, v108
  v_mul_f32 v249, v109, v109
  buffer_load_dwordx4 a[240:243], v24, s[88:91], s15 offen offset:2048 sc1
  v_mul_f32 v250, v110, v110
  v_mfma_f32_32x32x16_bf16 v[144:159], a[12:15], a[140:143], v[144:159]
  v_mul_f32 v251, v111, v111
  v_fma_f32 v236, v236, v61, v60
  v_fma_f32 v237, v237, v61, v60
  v_fma_f32 v238, v238, v61, v60
  v_fma_f32 v239, v239, v61, v60
  v_fma_f32 v240, v240, v61, v60
  s_waitcnt vmcnt(28)
  v_mfma_f32_32x32x16_bf16 v[64:79], a[16:19], a[144:147], v[64:79]
  buffer_load_dwordx4 a[244:247], v25, s[88:91], s15 offen offset:2048 sc1
  v_fma_f32 v241, v241, v61, v60
  v_fma_f32 v242, v242, v61, v60
  v_fma_f32 v243, v243, v61, v60
  v_fma_f32 v244, v244, v61, v60
  v_fma_f32 v245, v245, v61, v60
  v_mfma_f32_32x32x16_bf16 v[80:95], a[20:23], a[144:147], v[80:95]
  v_fma_f32 v246, v246, v61, v60
  v_fma_f32 v247, v247, v61, v60
  v_fma_f32 v248, v248, v61, v60
  buffer_load_dwordx4 a[248:251], v24, s[88:91], s15 offen offset:3072 sc1
  s_waitcnt vmcnt(29)
  v_mfma_f32_32x32x16_bf16 v[128:143], a[16:19], a[148:151], v[128:143]
  v_fma_f32 v249, v249, v61, v60
  v_fma_f32 v250, v250, v61, v60
  v_fma_f32 v251, v251, v61, v60
  v_mul_f32 v236, v236, v96
  v_mul_f32 v237, v237, v97
  v_mul_f32 v238, v238, v98
  v_mfma_f32_32x32x16_bf16 v[144:159], a[20:23], a[148:151], v[144:159]
  buffer_load_dwordx4 a[252:255], v25, s[88:91], s15 offen offset:3072 sc1
  v_mul_f32 v239, v239, v99
  v_mul_f32 v240, v240, v100
  v_mul_f32 v241, v241, v101
  v_mul_f32 v242, v242, v102
  v_mul_f32 v243, v243, v103
  s_waitcnt vmcnt(29)
  v_mfma_f32_32x32x16_bf16 v[64:79], a[24:27], a[152:155], v[64:79]
  v_mul_f32 v244, v244, v104
  v_mul_f32 v245, v245, v105
  s_add_u32 s14, s14, 4096
  s_and_b32 s14, s14, 32767
  v_add_u32 v21, 0x8000, v21
  v_add_u32 v22, 0x8000, v22
  buffer_load_dwordx4 a[128:131], v21, s[88:91], s14 offen offset:0
  v_mfma_f32_32x32x16_bf16 v[80:95], a[28:31], a[152:155], v[80:95]
  v_mul_f32 v246, v246, v106
  v_mul_f32 v247, v247, v107
  v_mul_f32 v248, v248, v108
  v_mul_f32 v249, v249, v109
  v_mul_f32 v250, v250, v110
  v_mul_f32 v251, v251, v111
  s_waitcnt vmcnt(29)
  v_mfma_f32_32x32x16_bf16 v[128:143], a[24:27], a[156:159], v[128:143]
  buffer_load_dwordx4 a[0:3], v22, s[88:91], s14 offen offset:0
  v_exp_f32 v236, v236
  v_exp_f32 v237, v237
  v_mfma_f32_32x32x16_bf16 v[144:159], a[28:31], a[156:159], v[144:159]
  s_waitcnt vmcnt(10)
  s_mov_b64 exec, 1
  s_cmp_lg_u32 s18, 0
  s_cbranch_scc1 L_slow_71
  buffer_store_dword v11, v12, s[88:91], s25 offen offset:1024
L_sret_72:
  s_mov_b64 exec, -1
  v_mfma_f32_32x32x16_bf16 v[64:79], a[32:35], a[160:163], v[64:79]
  v_exp_f32 v238, v238
  v_exp_f32 v239, v239
  v_exp_f32 v240, v240
  buffer_load_dwordx4 a[132:135], v21, s[88:91], s14 offen offset:2048
  v_mfma_f32_32x32x16_bf16 v[80:95], a[36:39], a[160:163], v[80:95]
  v_exp_f32 v241, v241
  v_exp_f32 v242, v242
  v_exp_f32 v243, v243
  v_mfma_f32_32x32x16_bf16 v[128:143], a[32:35], a[164:167], v[128:143]
  buffer_load_dwordx4 a[4:7], v22, s[88:91], s14 offen offset:2048
  v_exp_f32 v244, v244
  v_exp_f32 v245, v245
  v_mfma_f32_32x32x16_bf16 v[144:159], a[36:39], a[164:167], v[144:159]
  v_exp_f32 v246, v246
  v_exp_f32 v247, v247
  s_add_u32 s14, s14, 4096
  s_and_b32 s14, s14, 32767
  buffer_load_dwordx4 a[136:139], v21, s[88:91], s14 offen offset:0
  v_mfma_f32_32x32x16_bf16 v[64:79], a[40:43], a[168:171], v[64:79]
  v_exp_f32 v248, v248
  v_exp_f32 v249, v249
  v_exp_f32 v250, v250
  v_mfma_f32_32x32x16_bf16 v[80:95], a[44:47], a[168:171], v[80:95]
  buffer_load_dwordx4 a[8:11], v22, s[88:91], s14 offen offset:0
  v_exp_f32 v251, v251
  v_fma_f32 v236, v236, v63, v63
  v_fma_f32 v237, v237, v63, v63
  v_fma_f32 v238, v238, v63, v63
  v_mfma_f32_32x32x16_bf16 v[128:143], a[40:43], a[172:175], v[128:143]
  v_fma_f32 v239, v239, v63, v63
  v_fma_f32 v240, v240, v63, v63
  v_fma_f32 v241, v241, v63, v63
  buffer_load_dwordx4 a[140:143], v21, s[88:91], s14 offen offset:2048
  v_mfma_f32_32x32x16_bf16 v[144:159], a[44:47], a[172:175], v[144:159]
  v_fma_f32 v242, v242, v63, v63
  v_fma_f32 v243, v243, v63, v63
  v_fma_f32 v244, v244, v63, v63
  v_fma_f32 v245, v245, v63, v63
  v_fma_f32 v246, v246, v63, v63
  v_fma_f32 v247, v247, v63, v63
  v_mfma_f32_32x32x16_bf16 v[64:79], a[48:51], a[176:179], v[64:79]
  buffer_load_dwordx4 a[12:15], v22, s[88:91], s14 offen offset:2048
  v_fma_f32 v248, v248, v63, v63
  v_fma_f32 v249, v249, v63, v63
  v_fma_f32 v250, v250, v63, v63
  v_fma_f32 v251, v251, v63, v63
  v_mfma_f32_32x32x16_bf16 v[80:95], a[52:55], a[176:179], v[80:95]
  v_rcp_f32 v236, v236
  v_rcp_f32 v237, v237
  s_add_u32 s14, s14, 4096
  s_and_b32 s14, s14, 32767
  buffer_load_dwordx4 a[144:147], v21, s[88:91], s14 offen offset:0
  v_mfma_f32_32x32x16_bf16 v[128:143], a[48:51], a[180:183], v[128:143]
  v_rcp_f32 v238, v238
  v_rcp_f32 v239, v239
  v_rcp_f32 v240, v240
  v_mfma_f32_32x32x16_bf16 v[144:159], a[52:55], a[180:183], v[144:159]
  buffer_load_dwordx4 a[16:19], v22, s[88:91], s14 offen offset:0
  v_rcp_f32 v241, v241
  v_rcp_f32 v242, v242
  v_mfma_f32_32x32x16_bf16 v[64:79], a[56:59], a[184:187], v[64:79]
  v_rcp_f32 v243, v243
  v_rcp_f32 v244, v244
  buffer_load_dwordx4 a[148:151], v21, s[88:91], s14 offen offset:2048
  v_mfma_f32_32x32x16_bf16 v[80:95], a[60:63], a[184:187], v[80:95]
  v_rcp_f32 v245, v245
  v_rcp_f32 v246, v246
  v_rcp_f32 v247, v247
  v_mfma_f32_32x32x16_bf16 v[128:143], a[56:59], a[188:191], v[128:143]
  buffer_load_dwordx4 a[20:23], v22, s[88:91], s14 offen offset:2048
  v_rcp_f32 v248, v248
  v_rcp_f32 v249, v249
  v_mfma_f32_32x32x16_bf16 v[144:159], a[60:63], a[188:191], v[144:159]
  buffer_load_dword v23, v13, s[88:91], s24 offen offset:1024 sc1
  v_rcp_f32 v250, v250
  v_rcp_f32 v251, v251
  v_mul_f32 v236, v236, v96
  v_mfma_f32_32x32x16_bf16 v[64:79], a[64:67], a[192:195], v[64:79]
  v_mul_f32 v237, v237, v97
  v_mul_f32 v238, v238, v98
  v_mul_f32 v239, v239, v99
  s_add_u32 s14, s14, 4096
  s_and_b32 s14, s14, 32767
  buffer_load_dwordx4 a[152:155], v21, s[88:91], s14 offen offset:0
  v_mfma_f32_32x32x16_bf16 v[80:95], a[68:71], a[192:195], v[80:95]
  v_mul_f32 v240, v240, v100
  v_mul_f32 v241, v241, v101
  v_mul_f32 v242, v242, v102
  v_mul_f32 v243, v243, v103
  v_mul_f32 v244, v244, v104
  v_mul_f32 v245, v245, v105
  v_mfma_f32_32x32x16_bf16 v[128:143], a[64:67], a[196:199], v[128:143]
  buffer_load_dwordx4 a[24:27], v22, s[88:91], s14 offen offset:0
  v_mul_f32 v246, v246, v106
  v_mul_f32 v247, v247, v107
  v_mul_f32 v248, v248, v108
  v_mul_f32 v249, v249, v109
  v_mul_f32 v250, v250, v110
  v_mfma_f32_32x32x16_bf16 v[144:159], a[68:71], a[196:199], v[144:159]
  v_mul_f32 v251, v251, v111
  v_cvt_pk_bf16_f32 v184, v236, v237
  v_cvt_pk_bf16_f32 v185, v238, v239
  buffer_load_dwordx4 a[156:159], v21, s[88:91], s14 offen offset:2048
  v_mfma_f32_32x32x16_bf16 v[64:79], a[72:75], a[200:203], v[64:79]
  v_cvt_pk_bf16_f32 v186, v240, v241
  v_cvt_pk_bf16_f32 v187, v242, v243
  v_cvt_pk_bf16_f32 v188, v244, v245
  v_cvt_pk_bf16_f32 v189, v246, v247
  v_cvt_pk_bf16_f32 v190, v248, v249
  v_cvt_pk_bf16_f32 v191, v250, v251
  v_mfma_f32_32x32x16_bf16 v[80:95], a[76:79], a[200:203], v[80:95]
  buffer_load_dwordx4 a[28:31], v22, s[88:91], s14 offen offset:2048
  buffer_store_dwordx4 v[184:187], v8, s[88:91], s43 offen offset:0 sc0 sc1
  buffer_store_dwordx4 v[188:191], v8, s[88:91], s43 offen offset:1024 sc0 sc1
  v_mfma_f32_32x32x16_bf16 v[128:143], a[72:75], a[204:207], v[128:143]
  s_waitcnt lgkmcnt(1)
  v_fmac_f32 v112, v220, v62
  v_fmac_f32 v113, v221, v62
  v_fmac_f32 v114, v222, v62
  v_fmac_f32 v115, v223, v62
  s_waitcnt lgkmcnt(0)
  v_fmac_f32 v116, v224, v62
  v_mfma_f32_32x32x16_bf16 v[144:159], a[76:79], a[204:207], v[144:159]
  s_add_u32 s14, s14, 4096
  s_and_b32 s14, s14, 32767
  buffer_load_dwordx4 a[160:163], v21, s[88:91], s14 offen offset:0
  v_fmac_f32 v117, v225, v62
  v_fmac_f32 v118, v226, v62
  v_fmac_f32 v119, v227, v62
  v_mfma_f32_32x32x16_bf16 v[64:79], a[80:83], a[208:211], v[64:79]
  v_mul_f32 v236, v112, v112
  v_mul_f32 v237, v113, v113
  v_mul_f32 v238, v114, v114
  v_mul_f32 v239, v115, v115
  v_mul_f32 v240, v116, v116
  buffer_load_dwordx4 a[32:35], v22, s[88:91], s14 offen offset:0
  v_mfma_f32_32x32x16_bf16 v[80:95], a[84:87], a[208:211], v[80:95]
  v_mul_f32 v241, v117, v117
  v_mul_f32 v242, v118, v118
  v_mul_f32 v243, v119, v119
  v_fma_f32 v236, v236, v61, v60
  v_fma_f32 v237, v237, v61, v60
  v_fma_f32 v238, v238, v61, v60
  v_mfma_f32_32x32x16_bf16 v[128:143], a[80:83], a[212:215], v[128:143]
  buffer_load_dwordx4 a[164:167], v21, s[88:91], s14 offen offset:2048
  v_fma_f32 v239, v239, v61, v60
  v_fma_f32 v240, v240, v61, v60
  v_fma_f32 v241, v241, v61, v60
  v_fma_f32 v242, v242, v61, v60
  v_fma_f32 v243, v243, v61, v60
  v_mfma_f32_32x32x16_bf16 v[144:159], a[84:87], a[212:215], v[144:159]
  v_mul_f32 v236, v236, v112
  v_mul_f32 v237, v237, v113
  v_mul_f32 v238, v238, v114
  buffer_load_dwordx4 a[36:39], v22, s[88:91], s14 offen offset:2048
  v_mfma_f32_32x32x16_bf16 v[64:79], a[88:91], a[216:219], v[64:79]
  v_mul_f32 v239, v239, v115
  v_mul_f32 v240, v240, v116
  v_mul_f32 v241, v241, v117
  v_mul_f32 v242, v242, v118
  v_mul_f32 v243, v243, v119
  v_mfma_f32_32x32x16_bf16 v[80:95], a[92:95], a[216:219], v[80:95]
  s_add_u32 s14, s14, 4096
  s_and_b32 s14, s14, 32767
  buffer_load_dwordx4 a[168:171], v21, s[88:91], s14 offen offset:0
  v_exp_f32 v236, v236
  v_mfma_f32_32x32x16_bf16 v[128:143], a[88:91], a[220:223], v[128:143]
  v_exp_f32 v237, v237
  v_exp_f32 v238, v238
  v_exp_f32 v239, v239
  buffer_load_dwordx4 a[40:43], v22, s[88:91], s14 offen offset:0
  v_mfma_f32_32x32x16_bf16 v[144:159], a[92:95], a[220:223], v[144:159]
  s_waitcnt vmcnt(12)
  v_cmp_ne_u32 vcc, v23, v11
  s_nop 1
  s_and_b64 vcc, vcc, s[40:41]
  s_cbranch_scc1 L_lz_73
L_lzr_74:
  v_mfma_f32_32x32x16_bf16 v[64:79], a[96:99], a[224:227], v[64:79]
  buffer_load_dwordx4 a[172:175], v26, s[88:91], s27 offen offset:0 sc1
  v_exp_f32 v240, v240
  v_exp_f32 v241, v241
  v_mfma_f32_32x32x16_bf16 v[80:95], a[100:103], a[224:227], v[80:95]
  v_exp_f32 v242, v242
  v_exp_f32 v243, v243
  buffer_load_dwordx4 a[44:47], v27, s[88:91], s27 offen offset:0 sc1
  v_mfma_f32_32x32x16_bf16 v[128:143], a[96:99], a[228:231], v[128:143]
  v_fma_f32 v236, v236, v63, v63
  v_fma_f32 v237, v237, v63, v63
  v_fma_f32 v238, v238, v63, v63
  v_fma_f32 v239, v239, v63, v63
  v_fma_f32 v240, v240, v63, v63
  v_fma_f32 v241, v241, v63, v63
  v_mfma_f32_32x32x16_bf16 v[144:159], a[100:103], a[228:231], v[144:159]
  buffer_load_dwordx4 a[176:179], v26, s[88:91], s27 offen offset:1024 sc1
  v_fma_f32 v242, v242, v63, v63
  v_fma_f32 v243, v243, v63, v63
  v_rcp_f32 v236, v236
  v_mfma_f32_32x32x16_bf16 v[64:79], a[104:107], a[232:235], v[64:79]
  v_rcp_f32 v237, v237
  v_rcp_f32 v238, v238
  buffer_load_dwordx4 a[48:51], v27, s[88:91], s27 offen offset:1024 sc1
  v_mfma_f32_32x32x16_bf16 v[80:95], a[108:111], a[232:235], v[80:95]
  v_rcp_f32 v239, v239
  v_rcp_f32 v240, v240
  v_rcp_f32 v241, v241
  v_mfma_f32_32x32x16_bf16 v[128:143], a[104:107], a[236:239], v[128:143]
  buffer_load_dwordx4 a[180:183], v26, s[88:91], s27 offen offset:2048 sc1
  v_rcp_f32 v242, v242
  v_rcp_f32 v243, v243
  v_mul_f32 v236, v236, v112
  v_mfma_f32_32x32x16_bf16 v[144:159], a[108:111], a[236:239], v[144:159]
  v_mul_f32 v237, v237, v113
  v_mul_f32 v238, v238, v114
  v_mul_f32 v239, v239, v115
  buffer_load_dwordx4 a[52:55], v27, s[88:91], s27 offen offset:2048 sc1
  v_mfma_f32_32x32x16_bf16 v[64:79], a[112:115], a[240:243], v[64:79]
  v_mul_f32 v240, v240, v116
  v_mul_f32 v241, v241, v117
  v_mul_f32 v242, v242, v118
  v_mul_f32 v243, v243, v119
  v_cvt_pk_bf16_f32 v176, v236, v237
L_stub6:
  s_cbranch_execz L_stubret
  v_cvt_pk_bf16_f32 v177, v238, v239
  v_mfma_f32_32x32x16_bf16 v[80:95], a[116:119], a[240:243], v[80:95]
  buffer_load_dwordx4 a[184:187], v26, s[88:91], s27 offen offset:3072 sc1
  v_cvt_pk_bf16_f32 v178, v240, v241
  v_cvt_pk_bf16_f32 v179, v242, v243
  buffer_store_dwordx4 v[176:179], v8, s[88:91], s43 offen offset:2048 sc0 sc1
  v_mfma_f32_32x32x16_bf16 v[128:143], a[112:115], a[244:247], v[128:143]
  s_lshl_b32 s7, s21, 7
  s_lshl_b32 s6, s22, 6
  s_add_u32 s7, s7, s6
  v_lshlrev_b32 v3, 4, v7
  buffer_load_dwordx4 v[28:31], v3, s[32:35], s7 offen
  buffer_load_dwordx4 v[56:59], v3, s[32:35], s7 offen offset:32
  v_mfma_f32_32x32x16_bf16 v[144:159], a[116:119], a[244:247], v[144:159]
  v_mfma_f32_32x32x16_bf16 v[64:79], a[120:123], a[248:251], v[64:79]
  buffer_load_dwordx4 a[56:59], v27, s[88:91], s27 offen offset:3072 sc1
  v_mfma_f32_32x32x16_bf16 v[80:95], a[124:127], a[248:251], v[80:95]
  v_mfma_f32_32x32x16_bf16 v[128:143], a[120:123], a[252:255], v[128:143]
  s_add_u32 s27, s27, 4096
  s_and_b32 s27, s27, 16383
  buffer_load_dwordx4 a[188:191], v26, s[88:91], s27 offen offset:0 sc1
  v_mfma_f32_32x32x16_bf16 v[144:159], a[124:127], a[252:255], v[144:159]
  v_lshlrev_b32 v176, 16, v48
  v_and_b32 v177, v10, v48
  v_lshlrev_b32 v178, 16, v49
  v_and_b32 v179, v10, v49
  v_lshlrev_b32 v180, 16, v50
  buffer_load_dwordx4 a[60:63], v27, s[88:91], s27 offen offset:0 sc1
  v_and_b32 v181, v10, v50
  v_lshlrev_b32 v182, 16, v51
  v_and_b32 v183, v10, v51
  v_lshlrev_b32 v184, 16, v52
  v_and_b32 v185, v10, v52
  v_lshlrev_b32 v186, 16, v53
  v_and_b32 v187, v10, v53
  v_lshlrev_b32 v188, 16, v54
  v_and_b32 v189, v10, v54
  v_lshlrev_b32 v190, 16, v55
  buffer_load_dwordx4 a[192:195], v26, s[88:91], s27 offen offset:1024 sc1
  v_and_b32 v191, v10, v55
  s_waitcnt vmcnt(13)
  s_nop 0
  v_mfma_f32_32x32x16_bf16 v[176:191], a[128:131], a[172:175], v[176:191]
  v_add_u32 v24, s36, v14
  v_add_u32 v25, s36, v15
  ds_write_b128 v16, v[80:83] offset:0
  buffer_load_dwordx4 a[64:67], v27, s[88:91], s27 offen offset:1024 sc1
  v_mfma_f32_32x32x16_bf16 v[96:111], a[0:3], a[172:175], 0
  ds_write_b128 v16, v[84:87] offset:1024
  s_waitcnt vmcnt(13)
  v_mfma_f32_32x32x16_bf16 v[112:127], a[128:131], a[44:47], 0
  buffer_load_dwordx4 a[196:199], v26, s[88:91], s27 offen offset:2048 sc1
  ds_write_b128 v16, v[88:91] offset:2048
  v_mfma_f32_32x32x16_bf16 v[160:175], a[0:3], a[44:47], 0
  ds_write_b128 v16, v[92:95] offset:3072
  buffer_load_dwordx4 a[68:71], v27, s[88:91], s27 offen offset:2048 sc1
  s_waitcnt vmcnt(14)
  v_mfma_f32_32x32x16_bf16 v[176:191], a[132:135], a[176:179], v[176:191]
  ds_write_b128 v18, v[128:131] offset:0
  v_mfma_f32_32x32x16_bf16 v[96:111], a[4:7], a[176:179], v[96:111]
  buffer_load_dwordx4 a[200:203], v26, s[88:91], s27 offen offset:3072 sc1
  ds_write_b128 v18, v[132:135] offset:1024
  s_waitcnt vmcnt(14)
  v_mfma_f32_32x32x16_bf16 v[112:127], a[132:135], a[48:51], v[112:127]
  ds_write_b128 v18, v[136:139] offset:2048
  buffer_load_dwordx4 a[72:75], v27, s[88:91], s27 offen offset:3072 sc1
  v_mfma_f32_32x32x16_bf16 v[160:175], a[4:7], a[48:51], v[160:175]
  s_waitcnt vmcnt(11)
  s_mov_b64 exec, 1
  s_cmp_lg_u32 s18, 0
  s_cbranch_scc1 L_slow_75
  buffer_store_dword v11, v12, s[88:91], s25 offen offset:1280
L_sret_76:
  s_mov_b64 exec, -1
  ds_write_b128 v18, v[140:143] offset:3072
  v_mfma_f32_32x32x16_bf16 v[176:191], a[136:139], a[180:183], v[176:191]
  ds_write_b128 v19, v[144:147] offset:0
  s_add_u32 s27, s27, 4096
  s_and_b32 s27, s27, 16383
  buffer_load_dwordx4 a[204:207], v26, s[88:91], s27 offen offset:0 sc1
  v_mfma_f32_32x32x16_bf16 v[96:111], a[8:11], a[180:183], v[96:111]
  ds_write_b128 v19, v[148:151] offset:1024
  v_mfma_f32_32x32x16_bf16 v[112:127], a[136:139], a[52:55], v[112:127]
  buffer_load_dwordx4 a[76:79], v27, s[88:91], s27 offen offset:0 sc1
  ds_write_b128 v19, v[152:155] offset:2048
  v_mfma_f32_32x32x16_bf16 v[160:175], a[8:11], a[52:55], v[160:175]
  ds_write_b128 v19, v[156:159] offset:3072
  buffer_load_dwordx4 a[208:211], v26, s[88:91], s27 offen offset:1024 sc1
  v_mfma_f32_32x32x16_bf16 v[176:191], a[140:143], a[184:187], v[176:191]
  s_waitcnt lgkmcnt(0)
  s_barrier
  ds_read_b128 v[80:83], v20 offset:0
  ds_read_b128 v[84:87], v20 offset:1024
  ds_read_b128 v[88:91], v20 offset:2048
  ds_read_b128 v[92:95], v20 offset:3072
  v_mfma_f32_32x32x16_bf16 v[96:111], a[12:15], a[184:187], v[96:111]
  buffer_load_dwordx4 a[80:83], v27, s[88:91], s27 offen offset:1024 sc1
  ds_read_b128 v[128:131], v20 offset:4096
  ds_read_b128 v[132:135], v20 offset:5120
  ds_read_b128 v[136:139], v20 offset:6144
  ds_read_b128 v[140:143], v20 offset:7168
  ds_read_b128 v[144:147], v20 offset:8192
  s_waitcnt vmcnt(13)
  v_mfma_f32_32x32x16_bf16 v[112:127], a[140:143], a[56:59], v[112:127]
  ds_read_b128 v[148:151], v20 offset:9216
  ds_read_b128 v[152:155], v20 offset:10240
  buffer_load_dwordx4 a[212:215], v26, s[88:91], s27 offen offset:2048 sc1
  ds_read_b128 v[156:159], v20 offset:11264
  s_waitcnt lgkmcnt(11)
  v_add_f32 v64, v64, v80
  v_mfma_f32_32x32x16_bf16 v[160:175], a[12:15], a[56:59], v[160:175]
  v_add_f32 v65, v65, v81
  v_add_f32 v66, v66, v82
  v_add_f32 v67, v67, v83
  s_waitcnt lgkmcnt(10)
  v_add_f32 v68, v68, v84
  buffer_load_dwordx4 a[84:87], v27, s[88:91], s27 offen offset:2048 sc1
  s_waitcnt vmcnt(14)
  v_mfma_f32_32x32x16_bf16 v[176:191], a[144:147], a[188:191], v[176:191]
  v_add_f32 v69, v69, v85
  v_add_f32 v70, v70, v86
  v_add_f32 v71, v71, v87
  s_waitcnt lgkmcnt(9)
  v_add_f32 v72, v72, v88
  buffer_load_dwordx4 a[216:219], v21, s[88:91], s14 offen offset:2048
  v_mfma_f32_32x32x16_bf16 v[96:111], a[16:19], a[188:191], v[96:111]
  v_add_f32 v73, v73, v89
  v_add_f32 v74, v74, v90
  v_add_f32 v75, v75, v91
  s_waitcnt lgkmcnt(8)
  v_add_f32 v76, v76, v92
  buffer_load_dwordx4 a[88:91], v22, s[88:91], s14 offen offset:2048
  s_waitcnt vmcnt(15)
  v_mfma_f32_32x32x16_bf16 v[112:127], a[144:147], a[60:63], v[112:127]
  v_add_f32 v77, v77, v93
  v_add_f32 v78, v78, v94
  v_add_f32 v79, v79, v95
  s_waitcnt lgkmcnt(7)
  v_add_f32 v64, v64, v128
  v_add_f32 v65, v65, v129
  v_mfma_f32_32x32x16_bf16 v[160:175], a[16:19], a[60:63], v[160:175]
  buffer_load_dwordx4 a[220:223], v26, s[88:91], s27 offen offset:3072 sc1
  v_add_f32 v66, v66, v130
  v_add_f32 v67, v67, v131
  s_waitcnt lgkmcnt(6)
  v_add_f32 v68, v68, v132
  v_add_f32 v69, v69, v133
  s_waitcnt vmcnt(15)
  v_mfma_f32_32x32x16_bf16 v[176:191], a[148:151], a[192:195], v[176:191]
  v_add_f32 v70, v70, v134
  v_add_f32 v71, v71, v135
  buffer_load_dwordx4 a[92:95], v27, s[88:91], s27 offen offset:3072 sc1
  s_waitcnt lgkmcnt(5)
  v_add_f32 v72, v72, v136
  v_mfma_f32_32x32x16_bf16 v[96:111], a[20:23], a[192:195], v[96:111]
  v_add_f32 v73, v73, v137
  v_add_f32 v74, v74, v138
  v_add_f32 v75, v75, v139
  s_add_u32 s14, s14, 4096
  s_and_b32 s14, s14, 32767
  buffer_load_dwordx4 a[224:227], v21, s[88:91], s14 offen offset:0
  s_waitcnt vmcnt(16)
  v_mfma_f32_32x32x16_bf16 v[112:127], a[148:151], a[64:67], v[112:127]
  s_waitcnt lgkmcnt(4)
  v_add_f32 v76, v76, v140
  v_add_f32 v77, v77, v141
  v_add_f32 v78, v78, v142
  buffer_load_dwordx4 a[96:99], v22, s[88:91], s14 offen offset:0
  v_mfma_f32_32x32x16_bf16 v[160:175], a[20:23], a[64:67], v[160:175]
  v_add_f32 v79, v79, v143
  s_waitcnt lgkmcnt(3)
  v_add_f32 v64, v64, v144
  v_add_f32 v65, v65, v145
  v_add_f32 v66, v66, v146
  v_add_f32 v67, v67, v147
  s_waitcnt vmcnt(16)
  v_mfma_f32_32x32x16_bf16 v[176:191], a[152:155], a[196:199], v[176:191]
  s_add_u32 s27, s27, 4096
  s_and_b32 s27, s27, 16383
  buffer_load_dwordx4 a[228:231], v26, s[88:91], s27 offen offset:0 sc1
  s_waitcnt lgkmcnt(2)
  v_add_f32 v68, v68, v148
  v_add_f32 v69, v69, v149
  v_mfma_f32_32x32x16_bf16 v[96:111], a[24:27], a[196:199], v[96:111]
  v_add_f32 v70, v70, v150
  v_add_f32 v71, v71, v151
  s_waitcnt lgkmcnt(1)
  v_add_f32 v72, v72, v152
  v_add_f32 v73, v73, v153
  buffer_load_dwordx4 a[100:103], v27, s[88:91], s27 offen offset:0 sc1
  s_waitcnt vmcnt(17)
  v_mfma_f32_32x32x16_bf16 v[112:127], a[152:155], a[68:71], v[112:127]
  v_add_f32 v74, v74, v154
  v_add_f32 v75, v75, v155
  s_waitcnt lgkmcnt(0)
  v_add_f32 v76, v76, v156
  buffer_load_dwordx4 a[232:235], v21, s[88:91], s14 offen offset:2048
  v_mfma_f32_32x32x16_bf16 v[160:175], a[24:27], a[68:71], v[160:175]
  buffer_load_dword v23, v13, s[88:91], s24 offen offset:1280 sc1
  v_add_f32 v77, v77, v157
  v_add_f32 v78, v78, v158
  v_add_f32 v79, v79, v159
  s_barrier
  v_lshlrev_b32 v80, 16, v36
  s_waitcnt vmcnt(18)
  v_mfma_f32_32x32x16_bf16 v[176:191], a[156:159], a[200:203], v[176:191]
  buffer_load_dwordx4 a[104:107], v22, s[88:91], s14 offen offset:2048
  v_and_b32 v81, v10, v36
  v_lshlrev_b32 v82, 16, v37
  v_and_b32 v83, v10, v37
  v_lshlrev_b32 v84, 16, v38
  v_and_b32 v85, v10, v38
  v_mfma_f32_32x32x16_bf16 v[96:111], a[28:31], a[200:203], v[96:111]
  v_lshlrev_b32 v86, 16, v39
  v_and_b32 v87, v10, v39
  v_lshlrev_b32 v88, 16, v40
  buffer_load_dwordx4 a[236:239], v26, s[88:91], s27 offen offset:1024 sc1
  s_waitcnt vmcnt(19)
  v_mfma_f32_32x32x16_bf16 v[112:127], a[156:159], a[72:75], v[112:127]
  v_and_b32 v89, v10, v40
  v_lshlrev_b32 v90, 16, v41
  v_and_b32 v91, v10, v41
  v_lshlrev_b32 v92, 16, v42
  v_and_b32 v93, v10, v42
  v_lshlrev_b32 v94, 16, v43
  v_mfma_f32_32x32x16_bf16 v[160:175], a[28:31], a[72:75], v[160:175]
  buffer_load_dwordx4 a[108:111], v27, s[88:91], s27 offen offset:1024 sc1
  v_and_b32 v95, v10, v43
  v_lshlrev_b32 v128, 16, v28
  v_and_b32 v129, v10, v28
  v_lshlrev_b32 v130, 16, v29
  v_and_b32 v131, v10, v29
  s_waitcnt vmcnt(18)
  v_mfma_f32_32x32x16_bf16 v[176:191], a[160:163], a[204:207], v[176:191]
  s_add_u32 s14, s14, 4096
  s_and_b32 s14, s14, 32767
  buffer_load_dwordx4 a[240:243], v21, s[88:91], s14 offen offset:0
  v_lshlrev_b32 v132, 16, v30
  v_and_b32 v133, v10, v30
  v_lshlrev_b32 v134, 16, v31
  v_mfma_f32_32x32x16_bf16 v[96:111], a[32:35], a[204:207], v[96:111]
  v_and_b32 v135, v10, v31
  v_lshlrev_b32 v136, 16, v56
  buffer_load_dwordx4 v[220:223], v22, s[88:91], s14 offen offset:0
  v_and_b32 v137, v10, v56
  s_waitcnt vmcnt(19)
  v_mfma_f32_32x32x16_bf16 v[112:127], a[160:163], a[76:79], v[112:127]
  v_lshlrev_b32 v138, 16, v57
  v_and_b32 v139, v10, v57
  v_lshlrev_b32 v140, 16, v58
  v_and_b32 v141, v10, v58
  v_lshlrev_b32 v142, 16, v59
  v_and_b32 v143, v10, v59
  buffer_load_dwordx4 v[224:227], v26, s[88:91], s27 offen offset:2048 sc1
  v_mfma_f32_32x32x16_bf16 v[160:175], a[32:35], a[76:79], v[160:175]
  v_fmac_f32 v64, v80, v128
  v_fmac_f32 v65, v81, v129
  v_fmac_f32 v66, v82, v130
  v_fmac_f32 v67, v83, v131
  v_fmac_f32 v68, v84, v132
  v_fmac_f32 v69, v85, v133
  s_waitcnt vmcnt(19)
  v_mfma_f32_32x32x16_bf16 v[176:191], a[164:167], a[208:211], v[176:191]
  buffer_load_dwordx4 v[228:231], v27, s[88:91], s27 offen offset:2048 sc1
  v_fmac_f32 v70, v86, v134
  v_fmac_f32 v71, v87, v135
  v_fmac_f32 v72, v88, v136
  v_fmac_f32 v73, v89, v137
  v_fmac_f32 v74, v90, v138
  v_mfma_f32_32x32x16_bf16 v[96:111], a[36:39], a[208:211], v[96:111]
  buffer_load_dwordx4 v[232:235], v21, s[88:91], s14 offen offset:2048
  v_fmac_f32 v75, v91, v139
  v_fmac_f32 v76, v92, v140
  v_fmac_f32 v77, v93, v141
  v_fmac_f32 v78, v94, v142
  v_fmac_f32 v79, v95, v143
  s_waitcnt vmcnt(20)
  v_mfma_f32_32x32x16_bf16 v[112:127], a[164:167], a[80:83], v[112:127]
  buffer_load_dwordx4 v[236:239], v22, s[88:91], s14 offen offset:2048
  buffer_load_dwordx4 v[28:31], v34, s[52:55], 0 offen
  buffer_load_dwordx4 v[56:59], v34, s[52:55], 0 offen offset:32
  v_mfma_f32_32x32x16_bf16 v[160:175], a[36:39], a[80:83], v[160:175]
  s_waitcnt vmcnt(22)
  v_mfma_f32_32x32x16_bf16 v[176:191], a[168:171], a[212:215], v[176:191]
  buffer_load_dwordx4 v[240:243], v26, s[88:91], s27 offen offset:3072 sc1
  v_mfma_f32_32x32x16_bf16 v[96:111], a[40:43], a[212:215], v[96:111]
  s_waitcnt vmcnt(22)
  v_mfma_f32_32x32x16_bf16 v[112:127], a[168:171], a[84:87], v[112:127]
  buffer_load_dwordx4 v[244:247], v27, s[88:91], s27 offen offset:3072 sc1
  v_mfma_f32_32x32x16_bf16 v[160:175], a[40:43], a[84:87], v[160:175]
  s_waitcnt vmcnt(13)
  v_cmp_ne_u32 vcc, v23, v11
  s_nop 1
  s_and_b64 vcc, vcc, s[40:41]
  s_cbranch_scc1 L_lz_77
L_lzr_78:
  s_mov_b32 s27, s38
  v_add_u32 v26, 0x4000, v26
  v_add_u32 v27, 0x4000, v27
  buffer_load_dwordx4 v[248:251], v26, s[88:91], s27 offen offset:0 sc1
  v_mfma_f32_32x32x16_bf16 v[176:191], a[216:219], a[220:223], v[176:191]
  v_mfma_f32_32x32x16_bf16 v[96:111], a[88:91], a[220:223], v[96:111]
  buffer_load_dwordx4 a[112:115], v27, s[88:91], s27 offen offset:0 sc1
  v_mfma_f32_32x32x16_bf16 v[112:127], a[216:219], a[92:95], v[112:127]
  v_mfma_f32_32x32x16_bf16 v[160:175], a[88:91], a[92:95], v[160:175]
  buffer_load_dwordx4 a[244:247], v26, s[88:91], s27 offen offset:1024 sc1
  v_mfma_f32_32x32x16_bf16 v[176:191], a[224:227], a[228:231], v[176:191]
  v_mfma_f32_32x32x16_bf16 v[96:111], a[96:99], a[228:231], v[96:111]
  buffer_load_dwordx4 a[116:119], v27, s[88:91], s27 offen offset:1024 sc1
  v_mfma_f32_32x32x16_bf16 v[112:127], a[224:227], a[100:103], v[112:127]
  v_mfma_f32_32x32x16_bf16 v[160:175], a[96:99], a[100:103], v[160:175]
  buffer_load_dwordx4 a[248:251], v26, s[88:91], s27 offen offset:2048 sc1
  s_waitcnt vmcnt(16)
  v_mfma_f32_32x32x16_bf16 v[176:191], a[232:235], a[236:239], v[176:191]
  v_mfma_f32_32x32x16_bf16 v[96:111], a[104:107], a[236:239], v[96:111]
  buffer_load_dwordx4 a[120:123], v27, s[88:91], s27 offen offset:2048 sc1
  s_waitcnt vmcnt(16)
  v_mfma_f32_32x32x16_bf16 v[112:127], a[232:235], a[108:111], v[112:127]
  v_mfma_f32_32x32x16_bf16 v[160:175], a[104:107], a[108:111], v[160:175]
  buffer_load_dwordx4 a[252:255], v26, s[88:91], s27 offen offset:3072 sc1
  ds_read_b128 v[200:203], v24 offset:0
  ds_read_b128 v[204:207], v25 offset:0
  s_waitcnt vmcnt(14)
  v_mfma_f32_32x32x16_bf16 v[176:191], a[240:243], v[224:227], v[176:191]
  v_mfma_f32_32x32x16_bf16 v[96:111], v[220:223], v[224:227], v[96:111]
  buffer_load_dwordx4 a[124:127], v27, s[88:91], s27 offen offset:3072 sc1
  s_waitcnt vmcnt(14)
  v_mfma_f32_32x32x16_bf16 v[112:127], a[240:243], v[228:231], v[112:127]
  v_mfma_f32_32x32x16_bf16 v[160:175], v[220:223], v[228:231], v[160:175]
  ds_read_b128 v[208:211], v24 offset:8192
  s_add_u32 s27, s27, 4096
  s_cmp_eq_u32 s27, 12288
  s_cselect_b32 s27, 0, s27
  buffer_load_dwordx4 a[172:175], v26, s[88:91], s27 offen offset:0 sc1
  ds_read_b128 v[212:215], v25 offset:8192
  s_waitcnt vmcnt(10)
  v_mfma_f32_32x32x16_bf16 v[176:191], v[232:235], v[240:243], v[176:191]
  v_mfma_f32_32x32x16_bf16 v[96:111], v[236:239], v[240:243], v[96:111]
  buffer_load_dwordx4 a[128:131], v27, s[88:91], s27 offen offset:0 sc1
  s_waitcnt vmcnt(10)
  v_mfma_f32_32x32x16_bf16 v[112:127], v[232:235], v[244:247], v[112:127]
  v_mfma_f32_32x32x16_bf16 v[160:175], v[236:239], v[244:247], v[160:175]
  ds_read_b128 v[192:195], v24 offset:16384
  buffer_load_dwordx4 a[44:47], v26, s[88:91], s27 offen offset:1024 sc1
  ds_read_b128 v[196:199], v25 offset:16384
  s_waitcnt vmcnt(10) lgkmcnt(5)
  v_mfma_f32_32x32x16_bf16 v[176:191], v[200:203], v[248:251], v[176:191]
  s_waitcnt lgkmcnt(4)
  v_mfma_f32_32x32x16_bf16 v[96:111], v[204:207], v[248:251], v[96:111]
  buffer_load_dwordx4 a[0:3], v27, s[88:91], s27 offen offset:1024 sc1
  s_waitcnt vmcnt(10)
  v_mfma_f32_32x32x16_bf16 v[112:127], v[200:203], a[112:115], v[112:127]
  v_mfma_f32_32x32x16_bf16 v[160:175], v[204:207], a[112:115], v[160:175]
  ds_read_b128 v[200:203], v24 offset:24576
  buffer_load_dwordx4 a[176:179], v26, s[88:91], s27 offen offset:2048 sc1
  ds_read_b128 v[204:207], v25 offset:24576
  s_waitcnt vmcnt(10) lgkmcnt(5)
  v_mfma_f32_32x32x16_bf16 v[176:191], v[208:211], a[244:247], v[176:191]
  s_waitcnt lgkmcnt(4)
  v_mfma_f32_32x32x16_bf16 v[96:111], v[212:215], a[244:247], v[96:111]
  buffer_load_dwordx4 a[132:135], v27, s[88:91], s27 offen offset:2048 sc1
  s_waitcnt vmcnt(10)
  v_mfma_f32_32x32x16_bf16 v[112:127], v[208:211], a[116:119], v[112:127]
  v_mfma_f32_32x32x16_bf16 v[160:175], v[212:215], a[116:119], v[160:175]
  ds_read_b128 v[208:211], v24 offset:32768
  buffer_load_dwordx4 a[48:51], v26, s[88:91], s27 offen offset:3072 sc1
  ds_read_b128 v[212:215], v25 offset:32768
  s_waitcnt vmcnt(10) lgkmcnt(5)
  v_mfma_f32_32x32x16_bf16 v[176:191], v[192:195], a[248:251], v[176:191]
  s_waitcnt lgkmcnt(4)
  v_mfma_f32_32x32x16_bf16 v[96:111], v[196:199], a[248:251], v[96:111]
  buffer_load_dwordx4 a[4:7], v27, s[88:91], s27 offen offset:3072 sc1
  s_waitcnt vmcnt(10)
  v_mfma_f32_32x32x16_bf16 v[112:127], v[192:195], a[120:123], v[112:127]
  v_mfma_f32_32x32x16_bf16 v[160:175], v[196:199], a[120:123], v[160:175]
  ds_read_b128 v[192:195], v24 offset:40960
  s_add_u32 s27, s27, 4096
  s_cmp_eq_u32 s27, 12288
  s_cselect_b32 s27, 0, s27
  buffer_load_dwordx4 a[180:183], v27, s[88:91], s27 offen offset:0 sc1
  ds_read_b128 v[196:199], v25 offset:40960
  s_waitcnt vmcnt(10) lgkmcnt(5)
  v_mfma_f32_32x32x16_bf16 v[176:191], v[200:203], a[252:255], v[176:191]
  s_waitcnt lgkmcnt(4)
  v_mfma_f32_32x32x16_bf16 v[96:111], v[204:207], a[252:255], v[96:111]
  buffer_load_dwordx4 a[136:139], v27, s[88:91], s27 offen offset:1024 sc1
  s_waitcnt vmcnt(10)
  v_mfma_f32_32x32x16_bf16 v[112:127], v[200:203], a[124:127], v[112:127]
  v_mfma_f32_32x32x16_bf16 v[160:175], v[204:207], a[124:127], v[160:175]
  ds_read_b128 v[200:203], v24 offset:49152
  buffer_load_dwordx4 a[52:55], v27, s[88:91], s27 offen offset:2048 sc1
  ds_read_b128 v[204:207], v25 offset:49152
  s_waitcnt vmcnt(10) lgkmcnt(5)
  v_mfma_f32_32x32x16_bf16 v[176:191], v[208:211], a[172:175], v[176:191]
  s_waitcnt lgkmcnt(4)
  v_mfma_f32_32x32x16_bf16 v[96:111], v[212:215], a[172:175], v[96:111]
  buffer_load_dwordx4 a[8:11], v27, s[88:91], s27 offen offset:3072 sc1
  s_waitcnt vmcnt(10)
  v_mfma_f32_32x32x16_bf16 v[112:127], v[208:211], a[128:131], v[112:127]
  v_mfma_f32_32x32x16_bf16 v[160:175], v[212:215], a[128:131], v[160:175]
  ds_read_b128 v[208:211], v24 offset:57344
  buffer_load_dwordx4 a[184:187], v26, s[88:91], s27 offen offset:0 sc1
  ds_read_b128 v[212:215], v25 offset:57344
  s_waitcnt vmcnt(10) lgkmcnt(5)
  v_mfma_f32_32x32x16_bf16 v[176:191], v[192:195], a[44:47], v[176:191]
  s_waitcnt lgkmcnt(4)
  v_mfma_f32_32x32x16_bf16 v[96:111], v[196:199], a[44:47], v[96:111]
  buffer_load_dwordx4 a[140:143], v26, s[88:91], s27 offen offset:1024 sc1
  s_waitcnt vmcnt(10)
  v_mfma_f32_32x32x16_bf16 v[112:127], v[192:195], a[0:3], v[112:127]
  v_mfma_f32_32x32x16_bf16 v[160:175], v[196:199], a[0:3], v[160:175]
  v_add_u32 v24, 0x10000, v24
  buffer_load_dwordx4 a[56:59], v26, s[88:91], s27 offen offset:2048 sc1
  v_add_u32 v25, 0x10000, v25
  ds_read_b128 v[192:195], v24 offset:0
  ds_read_b128 v[196:199], v25 offset:0
  s_waitcnt vmcnt(10) lgkmcnt(5)
  v_mfma_f32_32x32x16_bf16 v[176:191], v[200:203], a[176:179], v[176:191]
  s_waitcnt lgkmcnt(4)
  v_mfma_f32_32x32x16_bf16 v[96:111], v[204:207], a[176:179], v[96:111]
  buffer_load_dwordx4 a[12:15], v26, s[88:91], s27 offen offset:3072 sc1
  s_waitcnt vmcnt(10)
  v_mfma_f32_32x32x16_bf16 v[112:127], v[200:203], a[132:135], v[112:127]
  v_mfma_f32_32x32x16_bf16 v[160:175], v[204:207], a[132:135], v[160:175]
  ds_read_b128 v[200:203], v24 offset:8192
  ds_read_b128 v[204:207], v25 offset:8192
  s_waitcnt vmcnt(9) lgkmcnt(5)
  v_mfma_f32_32x32x16_bf16 v[176:191], v[208:211], a[48:51], v[176:191]
  s_waitcnt lgkmcnt(4)
  v_mfma_f32_32x32x16_bf16 v[96:111], v[212:215], a[48:51], v[96:111]
  s_waitcnt vmcnt(8)
  v_mfma_f32_32x32x16_bf16 v[112:127], v[208:211], a[4:7], v[112:127]
  v_mfma_f32_32x32x16_bf16 v[160:175], v[212:215], a[4:7], v[160:175]
  ds_read_b128 v[208:211], v24 offset:16384
  s_waitcnt vmcnt(7) lgkmcnt(4)
  v_mfma_f32_32x32x16_bf16 v[112:127], v[192:195], a[180:183], v[112:127]
  ds_read_b128 v[212:215], v25 offset:16384
  s_waitcnt lgkmcnt(4)
  v_mfma_f32_32x32x16_bf16 v[160:175], v[196:199], a[180:183], v[160:175]
  ds_read_b128 v[192:195], v24 offset:24576
  s_waitcnt vmcnt(6) lgkmcnt(4)
  v_mfma_f32_32x32x16_bf16 v[112:127], v[200:203], a[136:139], v[112:127]
  ds_read_b128 v[196:199], v25 offset:24576
  s_waitcnt lgkmcnt(4)
  v_mfma_f32_32x32x16_bf16 v[160:175], v[204:207], a[136:139], v[160:175]
  ds_read_b128 v[200:203], v25 offset:0
  s_waitcnt vmcnt(5) lgkmcnt(4)
  v_mfma_f32_32x32x16_bf16 v[112:127], v[208:211], a[52:55], v[112:127]
  ds_read_b128 v[204:207], v24 offset:0
  s_waitcnt lgkmcnt(4)
  v_mfma_f32_32x32x16_bf16 v[160:175], v[212:215], a[52:55], v[160:175]
  ds_read_b128 v[208:211], v25 offset:8192
  s_waitcnt vmcnt(4) lgkmcnt(4)
  v_mfma_f32_32x32x16_bf16 v[112:127], v[192:195], a[8:11], v[112:127]
  ds_read_b128 v[212:215], v24 offset:8192
  s_waitcnt lgkmcnt(4)
  v_mfma_f32_32x32x16_bf16 v[160:175], v[196:199], a[8:11], v[160:175]
  ds_read_b128 v[192:195], v25 offset:16384
  s_waitcnt vmcnt(3) lgkmcnt(4)
  v_mfma_f32_32x32x16_bf16 v[96:111], v[200:203], a[184:187], v[96:111]
  ds_read_b128 v[196:199], v25 offset:24576
  s_waitcnt lgkmcnt(4)
  v_mfma_f32_32x32x16_bf16 v[176:191], v[204:207], a[184:187], v[176:191]
  s_nop 2
  ds_write_b128 v18, v[112:115] offset:0
  ds_write_b128 v18, v[116:119] offset:1024
  ds_read_b128 v[200:203], v24 offset:16384
  s_waitcnt vmcnt(2) lgkmcnt(6)
  v_mfma_f32_32x32x16_bf16 v[96:111], v[208:211], a[140:143], v[96:111]
  ds_write_b128 v18, v[120:123] offset:2048
  ds_write_b128 v18, v[124:127] offset:3072
  ds_read_b128 v[204:207], v24 offset:24576
  s_waitcnt lgkmcnt(8)
  v_mfma_f32_32x32x16_bf16 v[176:191], v[212:215], a[140:143], v[176:191]
  ds_write_b128 v19, v[160:163] offset:0
  ds_write_b128 v19, v[164:167] offset:1024
  s_waitcnt vmcnt(1) lgkmcnt(9)
  v_mfma_f32_32x32x16_bf16 v[96:111], v[192:195], a[56:59], v[96:111]
  ds_write_b128 v19, v[168:171] offset:2048
  ds_write_b128 v19, v[172:175] offset:3072
  s_waitcnt vmcnt(0) lgkmcnt(10)
  v_mfma_f32_32x32x16_bf16 v[96:111], v[196:199], a[12:15], v[96:111]
  s_waitcnt lgkmcnt(0)
  s_barrier
  ds_read_b128 v[112:115], v20 offset:4096
  ds_read_b128 v[116:119], v20 offset:5120
  ds_read_b128 v[120:123], v20 offset:6144
  ds_read_b128 v[124:127], v20 offset:7168
  v_mfma_f32_32x32x16_bf16 v[176:191], v[200:203], a[56:59], v[176:191]
  ds_read_b128 v[160:163], v20 offset:8192
  ds_read_b128 v[164:167], v20 offset:9216
  ds_read_b128 v[168:171], v20 offset:10240
  ds_read_b128 v[172:175], v20 offset:11264
  v_mfma_f32_32x32x16_bf16 v[176:191], v[204:207], a[12:15], v[176:191]
  ds_write_b128 v16, v[96:99] offset:0
  ds_write_b128 v16, v[100:103] offset:1024
  ds_write_b128 v16, v[104:107] offset:2048
  ds_write_b128 v16, v[108:111] offset:3072
  v_mov_b32 v32, 0xbfb8aa3b
  v_mov_b32 v33, 1.0
  v_lshlrev_b32 v2, 1, v34
  v_lshlrev_b32 v192, 16, v28
  v_and_b32 v193, v10, v28
  v_lshlrev_b32 v194, 16, v29
  v_and_b32 v195, v10, v29
  v_lshlrev_b32 v196, 16, v30
  v_and_b32 v197, v10, v30
  v_lshlrev_b32 v198, 16, v31
  v_and_b32 v199, v10, v31
  v_lshlrev_b32 v200, 16, v56
  v_and_b32 v201, v10, v56
  v_lshlrev_b32 v202, 16, v57
  v_and_b32 v203, v10, v57
  v_lshlrev_b32 v204, 16, v58
  v_and_b32 v205, v10, v58
  v_lshlrev_b32 v206, 16, v59
  v_and_b32 v207, v10, v59
  s_waitcnt lgkmcnt(0)
  s_barrier
  ds_read_b128 v[96:99], v20 offset:0
  ds_read_b128 v[100:103], v20 offset:1024
  ds_read_b128 v[104:107], v20 offset:2048
  ds_read_b128 v[108:111], v20 offset:3072
  v_pk_add_f32 v[176:177], v[176:177], v[112:113]
  v_pk_add_f32 v[178:179], v[178:179], v[114:115]
  v_pk_add_f32 v[180:181], v[180:181], v[116:117]
  v_pk_add_f32 v[182:183], v[182:183], v[118:119]
  v_pk_add_f32 v[184:185], v[184:185], v[120:121]
  v_pk_add_f32 v[186:187], v[186:187], v[122:123]
  v_pk_add_f32 v[188:189], v[188:189], v[124:125]
  v_pk_add_f32 v[190:191], v[190:191], v[126:127]
  v_pk_add_f32 v[176:177], v[176:177], v[160:161]
  v_pk_add_f32 v[178:179], v[178:179], v[162:163]
  v_pk_add_f32 v[180:181], v[180:181], v[164:165]
  v_pk_add_f32 v[182:183], v[182:183], v[166:167]
  v_pk_add_f32 v[184:185], v[184:185], v[168:169]
  v_pk_add_f32 v[186:187], v[186:187], v[170:171]
  v_pk_add_f32 v[188:189], v[188:189], v[172:173]
  v_pk_add_f32 v[190:191], v[190:191], v[174:175]
  s_waitcnt lgkmcnt(3)
  v_pk_add_f32 v[176:177], v[176:177], v[96:97]
  v_pk_add_f32 v[178:179], v[178:179], v[98:99]
  v_pk_mul_f32 v[112:113], v[176:177], v[32:33] op_sel_hi:[1,0]
  v_pk_mul_f32 v[114:115], v[178:179], v[32:33] op_sel_hi:[1,0]
  v_exp_f32 v112, v112
  v_exp_f32 v113, v113
  v_exp_f32 v114, v114
  v_exp_f32 v115, v115
  v_pk_mul_f32 v[176:177], v[176:177], v[64:65]
  v_pk_mul_f32 v[178:179], v[178:179], v[66:67]
  v_pk_add_f32 v[112:113], v[112:113], v[32:33] op_sel:[0,1] op_sel_hi:[1,1]
  v_pk_add_f32 v[114:115], v[114:115], v[32:33] op_sel:[0,1] op_sel_hi:[1,1]
  v_rcp_f32 v112, v112
  v_rcp_f32 v113, v113
  v_rcp_f32 v114, v114
  v_rcp_f32 v115, v115
  v_pk_fma_f32 v[176:177], v[176:177], v[112:113], v[192:193]
  v_pk_fma_f32 v[178:179], v[178:179], v[114:115], v[194:195]
  buffer_store_dwordx4 v[176:179], v2, s[44:47], 0 offen offset:0
  s_waitcnt lgkmcnt(2)
  v_pk_add_f32 v[180:181], v[180:181], v[100:101]
  v_pk_add_f32 v[182:183], v[182:183], v[102:103]
  v_pk_mul_f32 v[116:117], v[180:181], v[32:33] op_sel_hi:[1,0]
  v_pk_mul_f32 v[118:119], v[182:183], v[32:33] op_sel_hi:[1,0]
  v_exp_f32 v116, v116
  v_exp_f32 v117, v117
  v_exp_f32 v118, v118
  v_exp_f32 v119, v119
  v_pk_mul_f32 v[180:181], v[180:181], v[68:69]
  v_pk_mul_f32 v[182:183], v[182:183], v[70:71]
  v_pk_add_f32 v[116:117], v[116:117], v[32:33] op_sel:[0,1] op_sel_hi:[1,1]
  v_pk_add_f32 v[118:119], v[118:119], v[32:33] op_sel:[0,1] op_sel_hi:[1,1]
  v_rcp_f32 v116, v116
  v_rcp_f32 v117, v117
  v_rcp_f32 v118, v118
  v_rcp_f32 v119, v119
  v_pk_fma_f32 v[180:181], v[180:181], v[116:117], v[196:197]
  v_pk_fma_f32 v[182:183], v[182:183], v[118:119], v[198:199]
  buffer_store_dwordx4 v[180:183], v2, s[44:47], 0 offen offset:16
  s_waitcnt lgkmcnt(1)
  v_pk_add_f32 v[184:185], v[184:185], v[104:105]
  v_pk_add_f32 v[186:187], v[186:187], v[106:107]
  v_pk_mul_f32 v[120:121], v[184:185], v[32:33] op_sel_hi:[1,0]
  v_pk_mul_f32 v[122:123], v[186:187], v[32:33] op_sel_hi:[1,0]
  v_exp_f32 v120, v120
  v_exp_f32 v121, v121
  v_exp_f32 v122, v122
  v_exp_f32 v123, v123
  v_pk_mul_f32 v[184:185], v[184:185], v[72:73]
  v_pk_mul_f32 v[186:187], v[186:187], v[74:75]
  v_pk_add_f32 v[120:121], v[120:121], v[32:33] op_sel:[0,1] op_sel_hi:[1,1]
  v_pk_add_f32 v[122:123], v[122:123], v[32:33] op_sel:[0,1] op_sel_hi:[1,1]
  v_rcp_f32 v120, v120
  v_rcp_f32 v121, v121
  v_rcp_f32 v122, v122
  v_rcp_f32 v123, v123
  v_pk_fma_f32 v[184:185], v[184:185], v[120:121], v[200:201]
  v_pk_fma_f32 v[186:187], v[186:187], v[122:123], v[202:203]
  buffer_store_dwordx4 v[184:187], v2, s[44:47], 0 offen offset:64
  s_waitcnt lgkmcnt(0)
  v_pk_add_f32 v[188:189], v[188:189], v[108:109]
  v_pk_add_f32 v[190:191], v[190:191], v[110:111]
  v_pk_mul_f32 v[124:125], v[188:189], v[32:33] op_sel_hi:[1,0]
  v_pk_mul_f32 v[126:127], v[190:191], v[32:33] op_sel_hi:[1,0]
  v_exp_f32 v124, v124
  v_exp_f32 v125, v125
  v_exp_f32 v126, v126
  v_exp_f32 v127, v127
  v_pk_mul_f32 v[188:189], v[188:189], v[76:77]
  v_pk_mul_f32 v[190:191], v[190:191], v[78:79]
  v_pk_add_f32 v[124:125], v[124:125], v[32:33] op_sel:[0,1] op_sel_hi:[1,1]
  v_pk_add_f32 v[126:127], v[126:127], v[32:33] op_sel:[0,1] op_sel_hi:[1,1]
  v_rcp_f32 v124, v124
  v_rcp_f32 v125, v125
  v_rcp_f32 v126, v126
  v_rcp_f32 v127, v127
  v_pk_fma_f32 v[188:189], v[188:189], v[124:125], v[204:205]
  v_pk_fma_f32 v[190:191], v[190:191], v[126:127], v[206:207]
  buffer_store_dwordx4 v[188:191], v2, s[44:47], 0 offen offset:80
  s_lshl_b32 s6, s2, 2
  s_add_u32 s6, s6, s5
  s_cmp_lg_u32 s6, 1020
  s_cbranch_scc1 L_end
  s_mov_b32 s6, 21495808
  s_mov_b64 exec, 1
  buffer_store_dword v11, v12, s[88:91], s6 offen sc0 sc1
L_end:
  s_endpgm
L_id_1:
  buffer_load_dword v30, v31, s[88:91], 0 offen sc1
  s_waitcnt vmcnt(0)
  v_and_b32 v2, -16, v30
  v_cmp_ne_u32 vcc, s17, v2
  s_add_u32 s13, s13, 1
  s_cmp_gt_u32 s13, 50000
  s_cbranch_scc1 L_idd_2
  s_cbranch_vccnz L_id_1
  s_branch L_idd_2
L_slow_3:
  buffer_store_dword v11, v12, s[88:91], s25 offen offset:256 sc0 sc1
  s_branch L_sret_4
L_lz_5:
  s_mov_b32 s13, 0
L_lz_5_p:
  buffer_load_dword v23, v13, s[88:91], s24 offen offset:256 sc1
  s_waitcnt vmcnt(0)
  v_cmp_ne_u32 vcc, v23, v11
  s_add_u32 s13, s13, 1
  s_cmp_gt_u32 s13, 50000
  s_cbranch_scc1 L_lzr_6
  s_and_b64 vcc, vcc, s[50:51]
  s_cbranch_scc1 L_lz_5_p
  s_branch L_lzr_6
L_slow_23:
  buffer_store_dwordx4 v[48:51], v8, s[88:91], s31 offen sc0 sc1
  buffer_store_dwordx4 v[52:55], v8, s[88:91], s31 offen offset:1024 sc0 sc1
  s_branch L_sret_24
L_slow_25:
  buffer_store_dwordx2 v[80:81], v8, s[88:91], s36 offen sc0 sc1
  s_branch L_sret_26
L_slow_27:
  s_waitcnt vmcnt(0)
  buffer_store_dword v11, v12, s[88:91], s25 offen offset:512 sc0 sc1
  s_branch L_sret_28
L_lz_29:
  s_mov_b32 s13, 0
L_lz_29_p:
  buffer_load_dword v23, v13, s[88:91], s24 offen offset:512 sc1
  s_waitcnt vmcnt(0)
  v_cmp_ne_u32 vcc, v23, v11
  s_add_u32 s13, s13, 1
  s_cmp_gt_u32 s13, 50000
  s_cbranch_scc1 L_lzr_30
L_stub7:
  s_cbranch_execz L_stubret
  s_and_b64 vcc, vcc, s[50:51]
  s_cbranch_scc1 L_lz_29_p
  s_branch L_lzr_30
L_wtf_47:
  buffer_load_dword v19, v20, s[88:91], 0 offen sc1
  s_waitcnt vmcnt(0)
  v_cmp_ne_u32 vcc, v19, v11
  s_add_u32 s13, s13, 1
  s_cmp_gt_u32 s13, 50000
  s_cbranch_scc1 L_wtfd_48
  s_cbranch_vccnz L_wtf_47
  s_branch L_wtfd_48
L_egslow:
  v_subrev_u32 v5, 0, v18
  buffer_load_dwordx4 v[220:223], v5, s[88:91], s48 offen sc1
  v_subrev_u32 v5, 16384, v18
  buffer_load_dwordx4 v[224:227], v5, s[88:91], s48 offen sc1
  v_subrev_u32 v5, 32768, v18
  buffer_load_dwordx4 v[228:231], v5, s[88:91], s48 offen sc1
  v_subrev_u32 v5, 49152, v18
  buffer_load_dwordx4 v[232:235], v5, s[88:91], s48 offen sc1
  v_subrev_u32 v5, 65536, v18
  buffer_load_dwordx4 v[236:239], v5, s[88:91], s48 offen sc1
  v_subrev_u32 v5, 81920, v18
  buffer_load_dwordx4 v[240:243], v5, s[88:91], s48 offen sc1
  v_subrev_u32 v5, 98304, v18
  buffer_load_dwordx4 v[244:247], v5, s[88:91], s48 offen sc1
  v_subrev_u32 v5, 114688, v18
  buffer_load_dwordx4 v[248:251], v5, s[88:91], s48 offen sc1
  s_waitcnt vmcnt(0)
  v_mov_b32 v2, 0
  v_cmp_le_i32 vcc, 0, v18
  v_xor_b32 v4, v221, v223
  s_nop 0
  v_cndmask_b32 v16, 0, v11, vcc
  v_xor_b32 v3, v221, v16
  v_or3_b32 v2, v2, v3, v4
  v_cmp_le_i32 vcc, 16384, v18
  v_xor_b32 v4, v225, v227
  s_nop 0
  v_cndmask_b32 v16, 0, v11, vcc
  v_xor_b32 v3, v225, v16
  v_or3_b32 v2, v2, v3, v4
  v_cmp_le_i32 vcc, 32768, v18
  v_xor_b32 v4, v229, v231
  s_nop 0
  v_cndmask_b32 v16, 0, v11, vcc
  v_xor_b32 v3, v229, v16
  v_or3_b32 v2, v2, v3, v4
  v_cmp_le_i32 vcc, 49152, v18
  v_xor_b32 v4, v233, v235
  s_nop 0
  v_cndmask_b32 v16, 0, v11, vcc
  v_xor_b32 v3, v233, v16
  v_or3_b32 v2, v2, v3, v4
  v_cmp_le_i32 vcc, 65536, v18
  v_xor_b32 v4, v237, v239
  s_nop 0
  v_cndmask_b32 v16, 0, v11, vcc
  v_xor_b32 v3, v237, v16
  v_or3_b32 v2, v2, v3, v4
  v_cmp_le_i32 vcc, 81920, v18
  v_xor_b32 v4, v241, v243
  s_nop 0
  v_cndmask_b32 v16, 0, v11, vcc
  v_xor_b32 v3, v241, v16
  v_or3_b32 v2, v2, v3, v4
  v_cmp_le_i32 vcc, 98304, v18
  v_xor_b32 v4, v245, v247
  s_nop 0
  v_cndmask_b32 v16, 0, v11, vcc
  v_xor_b32 v3, v245, v16
  v_or3_b32 v2, v2, v3, v4
  v_cmp_le_i32 vcc, 114688, v18
  v_xor_b32 v4, v249, v251
  s_nop 0
  v_cndmask_b32 v16, 0, v11, vcc
  v_xor_b32 v3, v249, v16
  v_or3_b32 v2, v2, v3, v4
  v_cmp_ne_u32 vcc, 0, v2
  s_add_u32 s13, s13, 1
  s_cmp_gt_u32 s13, 50000
  s_cbranch_scc1 L_egok
  s_cbranch_vccnz L_egslow
  s_branch L_egok
L_slow_59:
  buffer_store_dword v11, v12, s[88:91], s25 offen offset:768 sc0 sc1
  s_branch L_sret_60
L_lz_69:
  s_mov_b32 s13, 0
L_lz_69_p:
  buffer_load_dword v23, v13, s[88:91], s24 offen offset:768 sc1
  s_waitcnt vmcnt(0)
  v_cmp_ne_u32 vcc, v23, v11
  s_add_u32 s13, s13, 1
  s_cmp_gt_u32 s13, 50000
  s_cbranch_scc1 L_lzr_70
  s_and_b64 vcc, vcc, s[40:41]
  s_cbranch_scc1 L_lz_69_p
  s_branch L_lzr_70
L_slow_71:
  buffer_store_dword v11, v12, s[88:91], s25 offen offset:1024 sc0 sc1
  s_branch L_sret_72
L_lz_73:
  s_mov_b32 s13, 0
L_lz_73_p:
  buffer_load_dword v23, v13, s[88:91], s24 offen offset:1024 sc1
  s_waitcnt vmcnt(0)
  v_cmp_ne_u32 vcc, v23, v11
  s_add_u32 s13, s13, 1
  s_cmp_gt_u32 s13, 50000
  s_cbranch_scc1 L_lzr_74
  s_and_b64 vcc, vcc, s[40:41]
  s_cbranch_scc1 L_lz_73_p
  s_branch L_lzr_74
L_slow_75:
  buffer_store_dword v11, v12, s[88:91], s25 offen offset:1280 sc0 sc1
  s_branch L_sret_76
L_lz_77:
  s_mov_b32 s13, 0
L_lz_77_p:
  buffer_load_dword v23, v13, s[88:91], s24 offen offset:1280 sc1
  s_waitcnt vmcnt(0)
  v_cmp_ne_u32 vcc, v23, v11
  s_add_u32 s13, s13, 1
  s_cmp_gt_u32 s13, 50000
  s_cbranch_scc1 L_lzr_78
  s_and_b64 vcc, vcc, s[40:41]
  s_cbranch_scc1 L_lz_77_p
  s_branch L_lzr_78
L_cold:
L_ck_7:
  s_mov_b32 s13, 0
  s_and_b32 s6, s21, 3
  s_add_u32 s6, s6, 0
  s_and_b32 s6, s6, 3
  s_lshl_b32 s6, s6, 12
L_ck_7_p:
  v_add_u32 v44, 0, v33
  buffer_load_dwordx4 a[128:131], v44, s[88:91], s6 offen offset:0 sc1
  v_add_u32 v45, 0, v33
  buffer_load_dwordx4 a[132:135], v45, s[88:91], s6 offen offset:1024 sc1
  s_waitcnt vmcnt(0)
  v_accvgpr_read_b32 v44, a128
  v_accvgpr_read_b32 v45, a132
  v_cmp_u_f32 vcc, v44, v45
  s_add_u32 s13, s13, 1
  s_cmp_gt_u32 s13, 8192
  s_cbranch_scc1 L_ckr_8
  s_cbranch_vccnz L_ck_7_p
  s_branch L_ckr_8
L_ck_9:
  s_mov_b32 s13, 0
  s_and_b32 s6, s21, 3
  s_add_u32 s6, s6, 0
  s_and_b32 s6, s6, 3
  s_lshl_b32 s6, s6, 12
L_ck_9_p:
  v_add_u32 v44, 0, v33
  buffer_load_dwordx4 a[136:139], v44, s[88:91], s6 offen offset:2048 sc1
  v_add_u32 v45, 0, v33
  buffer_load_dwordx4 a[140:143], v45, s[88:91], s6 offen offset:3072 sc1
  s_waitcnt vmcnt(0)
  v_accvgpr_read_b32 v44, a136
  v_accvgpr_read_b32 v45, a140
  v_cmp_u_f32 vcc, v44, v45
  s_add_u32 s13, s13, 1
  s_cmp_gt_u32 s13, 8192
  s_cbranch_scc1 L_ckr_10
  s_cbranch_vccnz L_ck_9_p
  s_branch L_ckr_10
L_ck_11:
  s_mov_b32 s13, 0
  s_and_b32 s6, s21, 3
  s_add_u32 s6, s6, 1
  s_and_b32 s6, s6, 3
  s_lshl_b32 s6, s6, 12
L_ck_11_p:
  v_add_u32 v44, 0, v33
  buffer_load_dwordx4 a[144:147], v44, s[88:91], s6 offen offset:0 sc1
  v_add_u32 v45, 0, v33
  buffer_load_dwordx4 a[148:151], v45, s[88:91], s6 offen offset:1024 sc1
  s_waitcnt vmcnt(0)
  v_accvgpr_read_b32 v44, a144
  v_accvgpr_read_b32 v45, a148
  v_cmp_u_f32 vcc, v44, v45
  s_add_u32 s13, s13, 1
  s_cmp_gt_u32 s13, 8192
  s_cbranch_scc1 L_ckr_12
  s_cbranch_vccnz L_ck_11_p
  s_branch L_ckr_12
L_ck_13:
  s_mov_b32 s13, 0
  s_and_b32 s6, s21, 3
  s_add_u32 s6, s6, 1
  s_and_b32 s6, s6, 3
  s_lshl_b32 s6, s6, 12
L_ck_13_p:
  v_add_u32 v44, 0, v33
  buffer_load_dwordx4 a[152:155], v44, s[88:91], s6 offen offset:2048 sc1
  v_add_u32 v45, 0, v33
  buffer_load_dwordx4 a[156:159], v45, s[88:91], s6 offen offset:3072 sc1
  s_waitcnt vmcnt(0)
  v_accvgpr_read_b32 v44, a152
  v_accvgpr_read_b32 v45, a156
  v_cmp_u_f32 vcc, v44, v45
  s_add_u32 s13, s13, 1
  s_cmp_gt_u32 s13, 8192
  s_cbranch_scc1 L_ckr_14
  s_cbranch_vccnz L_ck_13_p
  s_branch L_ckr_14
L_ck_15:
  s_mov_b32 s13, 0
  s_and_b32 s6, s21, 3
  s_add_u32 s6, s6, 2
  s_and_b32 s6, s6, 3
  s_lshl_b32 s6, s6, 12
L_ck_15_p:
  v_add_u32 v44, 0, v33
  buffer_load_dwordx4 a[160:163], v44, s[88:91], s6 offen offset:0 sc1
  v_add_u32 v45, 0, v33
  buffer_load_dwordx4 a[164:167], v45, s[88:91], s6 offen offset:1024 sc1
  s_waitcnt vmcnt(0)
  v_accvgpr_read_b32 v44, a160
  v_accvgpr_read_b32 v45, a164
  v_cmp_u_f32 vcc, v44, v45
  s_add_u32 s13, s13, 1
  s_cmp_gt_u32 s13, 8192
  s_cbranch_scc1 L_ckr_16
  s_cbranch_vccnz L_ck_15_p
  s_branch L_ckr_16
L_ck_17:
  s_mov_b32 s13, 0
  s_and_b32 s6, s21, 3
  s_add_u32 s6, s6, 2
  s_and_b32 s6, s6, 3
  s_lshl_b32 s6, s6, 12
L_ck_17_p:
  v_add_u32 v44, 0, v33
  buffer_load_dwordx4 a[168:171], v44, s[88:91], s6 offen offset:2048 sc1
  v_add_u32 v45, 0, v33
  buffer_load_dwordx4 a[172:175], v45, s[88:91], s6 offen offset:3072 sc1
  s_waitcnt vmcnt(0)
  v_accvgpr_read_b32 v44, a168
  v_accvgpr_read_b32 v45, a172
  v_cmp_u_f32 vcc, v44, v45
  s_add_u32 s13, s13, 1
  s_cmp_gt_u32 s13, 8192
  s_cbranch_scc1 L_ckr_18
  s_cbranch_vccnz L_ck_17_p
  s_branch L_ckr_18
L_ck_19:
  s_mov_b32 s13, 0
  s_and_b32 s6, s21, 3
  s_add_u32 s6, s6, 3
  s_and_b32 s6, s6, 3
  s_lshl_b32 s6, s6, 12
L_ck_19_p:
  v_add_u32 v44, 0, v33
  buffer_load_dwordx4 a[176:179], v44, s[88:91], s6 offen offset:0 sc1
  v_add_u32 v45, 0, v33
  buffer_load_dwordx4 a[180:183], v45, s[88:91], s6 offen offset:1024 sc1
  s_waitcnt vmcnt(0)
  v_accvgpr_read_b32 v44, a176
  v_accvgpr_read_b32 v45, a180
  v_cmp_u_f32 vcc, v44, v45
  s_add_u32 s13, s13, 1
  s_cmp_gt_u32 s13, 8192
  s_cbranch_scc1 L_ckr_20
  s_cbranch_vccnz L_ck_19_p
  s_branch L_ckr_20
L_ck_21:
  s_mov_b32 s13, 0
  s_and_b32 s6, s21, 3
  s_add_u32 s6, s6, 3
  s_and_b32 s6, s6, 3
  s_lshl_b32 s6, s6, 12
L_ck_21_p:
  v_add_u32 v44, 0, v33
  buffer_load_dwordx4 a[184:187], v44, s[88:91], s6 offen offset:2048 sc1
  v_add_u32 v45, 0, v33
  buffer_load_dwordx4 a[188:191], v45, s[88:91], s6 offen offset:3072 sc1
  s_waitcnt vmcnt(0)
  v_accvgpr_read_b32 v44, a184
  v_accvgpr_read_b32 v45, a188
  v_cmp_u_f32 vcc, v44, v45
  s_add_u32 s13, s13, 1
  s_cmp_gt_u32 s13, 8192
  s_cbranch_scc1 L_ckr_22
  s_cbranch_vccnz L_ck_21_p
  s_branch L_ckr_22
L_ck_31:
  s_mov_b32 s13, 0
  s_and_b32 s6, s4, 3
  s_add_u32 s6, s6, 0
  s_and_b32 s6, s6, 3
  s_lshl_b32 s6, s6, 12
L_ck_31_p:
  v_add_u32 v44, 0, v33
  buffer_load_dwordx4 a[128:131], v44, s[88:91], s6 offen offset:0 sc1
  v_add_u32 v45, 0, v33
  buffer_load_dwordx4 a[132:135], v45, s[88:91], s6 offen offset:1024 sc1
  s_waitcnt vmcnt(0)
  v_accvgpr_read_b32 v44, a128
  v_accvgpr_read_b32 v45, a132
  v_cmp_u_f32 vcc, v44, v45
  s_add_u32 s13, s13, 1
  s_cmp_gt_u32 s13, 8192
  s_cbranch_scc1 L_ckr_32
  s_cbranch_vccnz L_ck_31_p
  s_branch L_ckr_32
L_sp_33:
  buffer_load_dwordx4 v[160:163], v8, s[88:91], s37 offen offset:0 sc1
  buffer_load_dwordx4 v[164:167], v8, s[88:91], s37 offen offset:1024 sc1
  buffer_load_dwordx4 v[168:171], v8, s[88:91], s37 offen offset:2048 sc1
  buffer_load_dwordx4 v[172:175], v8, s[88:91], s37 offen offset:3072 sc1
  s_waitcnt vmcnt(0)
  v_max3_u32 v16, v160, v162, v164
  v_max3_u32 v16, v16, v166, v168
  v_max3_u32 v16, v16, v170, v172
  v_cmp_u_f32 vcc, v16, v174
  s_add_u32 s13, s13, 1
  s_cmp_gt_u32 s13, 8192
  s_cbranch_scc1 L_spd_34
  s_cbranch_vccnz L_sp_33
  s_branch L_spd_34
L_ck_35:
  s_mov_b32 s13, 0
  s_and_b32 s6, s4, 3
  s_add_u32 s6, s6, 0
  s_and_b32 s6, s6, 3
  s_lshl_b32 s6, s6, 12
L_ck_35_p:
  v_add_u32 v44, 0, v33
  buffer_load_dwordx4 a[136:139], v44, s[88:91], s6 offen offset:2048 sc1
  v_add_u32 v45, 0, v33
  buffer_load_dwordx4 a[140:143], v45, s[88:91], s6 offen offset:3072 sc1
  s_waitcnt vmcnt(0)
  v_accvgpr_read_b32 v44, a136
  v_accvgpr_read_b32 v45, a140
  v_cmp_u_f32 vcc, v44, v45
  s_add_u32 s13, s13, 1
  s_cmp_gt_u32 s13, 8192
  s_cbranch_scc1 L_ckr_36
  s_cbranch_vccnz L_ck_35_p
  s_branch L_ckr_36
L_ck_37:
  s_mov_b32 s13, 0
  s_and_b32 s6, s4, 3
  s_add_u32 s6, s6, 1
  s_and_b32 s6, s6, 3
  s_lshl_b32 s6, s6, 12
L_ck_37_p:
  v_add_u32 v44, 0, v33
  buffer_load_dwordx4 a[144:147], v44, s[88:91], s6 offen offset:0 sc1
  v_add_u32 v45, 0, v33
  buffer_load_dwordx4 a[148:151], v45, s[88:91], s6 offen offset:1024 sc1
  s_waitcnt vmcnt(0)
  v_accvgpr_read_b32 v44, a144
  v_accvgpr_read_b32 v45, a148
  v_cmp_u_f32 vcc, v44, v45
  s_add_u32 s13, s13, 1
  s_cmp_gt_u32 s13, 8192
  s_cbranch_scc1 L_ckr_38
  s_cbranch_vccnz L_ck_37_p
  s_branch L_ckr_38
L_ck_39:
  s_mov_b32 s13, 0
  s_and_b32 s6, s4, 3
  s_add_u32 s6, s6, 1
  s_and_b32 s6, s6, 3
  s_lshl_b32 s6, s6, 12
L_ck_39_p:
  v_add_u32 v44, 0, v33
  buffer_load_dwordx4 a[152:155], v44, s[88:91], s6 offen offset:2048 sc1
  v_add_u32 v45, 0, v33
  buffer_load_dwordx4 a[156:159], v45, s[88:91], s6 offen offset:3072 sc1
  s_waitcnt vmcnt(0)
  v_accvgpr_read_b32 v44, a152
  v_accvgpr_read_b32 v45, a156
  v_cmp_u_f32 vcc, v44, v45
  s_add_u32 s13, s13, 1
  s_cmp_gt_u32 s13, 8192
  s_cbranch_scc1 L_ckr_40
  s_cbranch_vccnz L_ck_39_p
  s_branch L_ckr_40
L_ck_41:
  s_mov_b32 s13, 0
  s_and_b32 s6, s4, 3
  s_add_u32 s6, s6, 2
  s_and_b32 s6, s6, 3
  s_lshl_b32 s6, s6, 12
L_ck_41_p:
  v_add_u32 v44, -16384, v33
  buffer_load_dwordx4 a[160:163], v44, s[88:91], s6 offen offset:0 sc1
  v_add_u32 v45, -16384, v33
  buffer_load_dwordx4 a[164:167], v45, s[88:91], s6 offen offset:1024 sc1
  s_waitcnt vmcnt(0)
  v_accvgpr_read_b32 v44, a160
  v_accvgpr_read_b32 v45, a164
  v_cmp_u_f32 vcc, v44, v45
  s_add_u32 s13, s13, 1
  s_cmp_gt_u32 s13, 8192
  s_cbranch_scc1 L_ckr_42
  s_cbranch_vccnz L_ck_41_p
  s_branch L_ckr_42
L_ck_43:
  s_mov_b32 s13, 0
  s_and_b32 s6, s4, 3
  s_add_u32 s6, s6, 2
  s_and_b32 s6, s6, 3
  s_lshl_b32 s6, s6, 12
L_ck_43_p:
  v_add_u32 v44, -16384, v33
  buffer_load_dwordx4 a[168:171], v44, s[88:91], s6 offen offset:2048 sc1
  v_add_u32 v45, -16384, v33
  buffer_load_dwordx4 a[172:175], v45, s[88:91], s6 offen offset:3072 sc1
  s_waitcnt vmcnt(0)
  v_accvgpr_read_b32 v44, a168
  v_accvgpr_read_b32 v45, a172
  v_cmp_u_f32 vcc, v44, v45
  s_add_u32 s13, s13, 1
  s_cmp_gt_u32 s13, 8192
  s_cbranch_scc1 L_ckr_44
  s_cbranch_vccnz L_ck_43_p
  s_branch L_ckr_44
L_ck_45:
  s_mov_b32 s13, 0
  s_and_b32 s6, s4, 3
  s_add_u32 s6, s6, 3
  s_and_b32 s6, s6, 3
  s_lshl_b32 s6, s6, 12
L_ck_45_p:
  v_add_u32 v44, -16384, v33
  buffer_load_dwordx4 a[176:179], v44, s[88:91], s6 offen offset:0 sc1
  v_add_u32 v45, -16384, v33
  buffer_load_dwordx4 a[180:183], v45, s[88:91], s6 offen offset:1024 sc1
  s_waitcnt vmcnt(0)
  v_accvgpr_read_b32 v44, a176
  v_accvgpr_read_b32 v45, a180
  v_cmp_u_f32 vcc, v44, v45
  s_add_u32 s13, s13, 1
  s_cmp_gt_u32 s13, 8192
  s_cbranch_scc1 L_ckr_46
  s_cbranch_vccnz L_ck_45_p
  s_branch L_ckr_46
L_ck_49:
  s_mov_b32 s13, 0
  s_and_b32 s6, s4, 3
  s_add_u32 s6, s6, 3
  s_and_b32 s6, s6, 3
  s_lshl_b32 s6, s6, 12
L_ck_49_p:
  v_add_u32 v44, -16384, v33
  buffer_load_dwordx4 a[184:187], v44, s[88:91], s6 offen offset:2048 sc1
  v_add_u32 v45, -16384, v33
  buffer_load_dwordx4 a[188:191], v45, s[88:91], s6 offen offset:3072 sc1
  s_waitcnt vmcnt(0)
  v_accvgpr_read_b32 v44, a184
  v_accvgpr_read_b32 v45, a188
  v_cmp_u_f32 vcc, v44, v45
  s_add_u32 s13, s13, 1
  s_cmp_gt_u32 s13, 8192
  s_cbranch_scc1 L_ckr_50
  s_cbranch_vccnz L_ck_49_p
  s_branch L_ckr_50
L_ck_51:
  s_mov_b32 s13, 0
  s_and_b32 s6, s4, 3
  s_add_u32 s6, s6, 4
  s_and_b32 s6, s6, 3
  s_lshl_b32 s6, s6, 12
L_ck_51_p:
  v_add_u32 v44, 0, v33
  buffer_load_dwordx4 a[192:195], v44, s[88:91], s6 offen offset:0 sc1
  v_add_u32 v45, 0, v33
  buffer_load_dwordx4 a[196:199], v45, s[88:91], s6 offen offset:1024 sc1
  s_waitcnt vmcnt(0)
  v_accvgpr_read_b32 v44, a192
  v_accvgpr_read_b32 v45, a196
  v_cmp_u_f32 vcc, v44, v45
  s_add_u32 s13, s13, 1
  s_cmp_gt_u32 s13, 8192
  s_cbranch_scc1 L_ckr_52
  s_cbranch_vccnz L_ck_51_p
  s_branch L_ckr_52
L_ck_53:
  s_mov_b32 s13, 0
  s_and_b32 s6, s4, 3
  s_add_u32 s6, s6, 4
  s_and_b32 s6, s6, 3
  s_lshl_b32 s6, s6, 12
L_ck_53_p:
  v_add_u32 v44, 0, v33
  buffer_load_dwordx4 a[200:203], v44, s[88:91], s6 offen offset:2048 sc1
  v_add_u32 v45, 0, v33
  buffer_load_dwordx4 a[204:207], v45, s[88:91], s6 offen offset:3072 sc1
  s_waitcnt vmcnt(0)
  v_accvgpr_read_b32 v44, a200
  v_accvgpr_read_b32 v45, a204
  v_cmp_u_f32 vcc, v44, v45
  s_add_u32 s13, s13, 1
  s_cmp_gt_u32 s13, 8192
  s_cbranch_scc1 L_ckr_54
  s_cbranch_vccnz L_ck_53_p
  s_branch L_ckr_54
L_ck_55:
  s_mov_b32 s13, 0
  s_and_b32 s6, s4, 3
  s_add_u32 s6, s6, 5
  s_and_b32 s6, s6, 3
  s_lshl_b32 s6, s6, 12
L_ck_55_p:
  v_add_u32 v44, 0, v33
  buffer_load_dwordx4 a[208:211], v44, s[88:91], s6 offen offset:0 sc1
  v_add_u32 v45, 0, v33
  buffer_load_dwordx4 a[212:215], v45, s[88:91], s6 offen offset:1024 sc1
  s_waitcnt vmcnt(0)
  v_accvgpr_read_b32 v44, a208
  v_accvgpr_read_b32 v45, a212
  v_cmp_u_f32 vcc, v44, v45
  s_add_u32 s13, s13, 1
  s_cmp_gt_u32 s13, 8192
  s_cbranch_scc1 L_ckr_56
  s_cbranch_vccnz L_ck_55_p
  s_branch L_ckr_56
L_ck_57:
  s_mov_b32 s13, 0
  s_and_b32 s6, s4, 3
  s_add_u32 s6, s6, 5
  s_and_b32 s6, s6, 3
  s_lshl_b32 s6, s6, 12
L_ck_57_p:
  v_add_u32 v44, 0, v33
  buffer_load_dwordx4 a[216:219], v44, s[88:91], s6 offen offset:2048 sc1
  v_add_u32 v45, 0, v33
  buffer_load_dwordx4 a[220:223], v45, s[88:91], s6 offen offset:3072 sc1
  s_waitcnt vmcnt(0)
  v_accvgpr_read_b32 v44, a216
  v_accvgpr_read_b32 v45, a220
  v_cmp_u_f32 vcc, v44, v45
  s_add_u32 s13, s13, 1
  s_cmp_gt_u32 s13, 8192
  s_cbranch_scc1 L_ckr_58
  s_cbranch_vccnz L_ck_57_p
  s_branch L_ckr_58
L_ck_61:
  s_mov_b32 s13, 0
  s_and_b32 s6, s4, 3
  s_add_u32 s6, s6, 6
  s_and_b32 s6, s6, 3
  s_lshl_b32 s6, s6, 12
L_ck_61_p:
  v_add_u32 v44, 0, v33
  buffer_load_dwordx4 a[224:227], v44, s[88:91], s6 offen offset:0 sc1
  v_add_u32 v45, 0, v33
  buffer_load_dwordx4 a[228:231], v45, s[88:91], s6 offen offset:1024 sc1
  s_waitcnt vmcnt(0)
  v_accvgpr_read_b32 v44, a224
  v_accvgpr_read_b32 v45, a228
  v_cmp_u_f32 vcc, v44, v45
  s_add_u32 s13, s13, 1
  s_cmp_gt_u32 s13, 8192
  s_cbranch_scc1 L_ckr_62
  s_cbranch_vccnz L_ck_61_p
  s_branch L_ckr_62
L_ck_63:
  s_mov_b32 s13, 0
  s_and_b32 s6, s4, 3
  s_add_u32 s6, s6, 6
  s_and_b32 s6, s6, 3
  s_lshl_b32 s6, s6, 12
L_ck_63_p:
  v_add_u32 v44, 0, v33
  buffer_load_dwordx4 a[232:235], v44, s[88:91], s6 offen offset:2048 sc1
  v_add_u32 v45, 0, v33
  buffer_load_dwordx4 a[236:239], v45, s[88:91], s6 offen offset:3072 sc1
  s_waitcnt vmcnt(0)
  v_accvgpr_read_b32 v44, a232
  v_accvgpr_read_b32 v45, a236
  v_cmp_u_f32 vcc, v44, v45
  s_add_u32 s13, s13, 1
  s_cmp_gt_u32 s13, 8192
  s_cbranch_scc1 L_ckr_64
  s_cbranch_vccnz L_ck_63_p
  s_branch L_ckr_64
L_ck_65:
  s_mov_b32 s13, 0
  s_and_b32 s6, s4, 3
  s_add_u32 s6, s6, 7
  s_and_b32 s6, s6, 3
  s_lshl_b32 s6, s6, 12
L_ck_65_p:
  v_add_u32 v44, 0, v33
  buffer_load_dwordx4 a[240:243], v44, s[88:91], s6 offen offset:0 sc1
  v_add_u32 v45, 0, v33
  buffer_load_dwordx4 a[244:247], v45, s[88:91], s6 offen offset:1024 sc1
  s_waitcnt vmcnt(0)
  v_accvgpr_read_b32 v44, a240
  v_accvgpr_read_b32 v45, a244
  v_cmp_u_f32 vcc, v44, v45
  s_add_u32 s13, s13, 1
  s_cmp_gt_u32 s13, 8192
  s_cbranch_scc1 L_ckr_66
  s_cbranch_vccnz L_ck_65_p
  s_branch L_ckr_66
L_ck_67:
  s_mov_b32 s13, 0
  s_and_b32 s6, s4, 3
  s_add_u32 s6, s6, 7
  s_and_b32 s6, s6, 3
  s_lshl_b32 s6, s6, 12
L_ck_67_p:
  v_add_u32 v44, 0, v33
  buffer_load_dwordx4 a[248:251], v44, s[88:91], s6 offen offset:2048 sc1
  v_add_u32 v45, 0, v33
  buffer_load_dwordx4 a[252:255], v45, s[88:91], s6 offen offset:3072 sc1
  s_waitcnt vmcnt(0)
  v_accvgpr_read_b32 v44, a248
  v_accvgpr_read_b32 v45, a252
  v_cmp_u_f32 vcc, v44, v45
  s_add_u32 s13, s13, 1
  s_cmp_gt_u32 s13, 8192
  s_cbranch_scc1 L_ckr_68
  s_cbranch_vccnz L_ck_67_p
  s_branch L_ckr_68
L_codeend:
.section .rodata,"a"
.p2align 6
.amdhsa_kernel recurrent_scan__ssm_conv_s5__mixer_s_mlp__prompt_kernel
  .amdhsa_next_free_vgpr 512
  .amdhsa_next_free_sgpr 102
  .amdhsa_accum_offset 256
  .amdhsa_group_segment_fixed_size 0
  .amdhsa_kernarg_size 136
  .amdhsa_user_sgpr_count 2
  .amdhsa_user_sgpr_kernarg_segment_ptr 1
  .amdhsa_system_sgpr_workgroup_id_x 1
.end_amdhsa_kernel
```
